```python
import torch

def _softmax(x, axis=-1):
    return torch.softmax(x, dim=axis)

def _gelu(x):
    return torch.nn.functional.gelu(x, approximate='tanh')

def _silu(x):
    return torch.nn.functional.silu(x)

def _sigmoid(x):
    return torch.sigmoid(x)

def _layernorm(x, axis=-1, eps=1e-05):
    m = x.mean(dim=axis, keepdim=True)
    v = x.var(dim=axis, keepdim=True, unbiased=False)
    return (x - m) / torch.sqrt(v + eps)

def _scatter_add(tgt, idx, src, axis=0):
    return tgt.clone().index_add_(axis, idx, src)

def _segment_sum(src, seg, n):
    out = torch.zeros((n,) + src.shape[1:], dtype=src.dtype)
    return out.index_add_(0, seg, src)

def _pad(x, pw):
    flat = tuple((v for pair in reversed(pw) for v in pair))
    return torch.nn.functional.pad(x, flat)
kernel_name = 'standalone__swin_window_attn__vision'

def setup_inputs():

    _w = lambda a: (lambda t: t.to(torch.bfloat16) if t.is_floating_point() else t)(torch.as_tensor(a))
    H = W = 512 // 7 * 7
    C, win = (96, 7)
    return {'x': _w((lambda *s: torch.randn(*s, dtype=torch.bfloat16) * 0.4)(1, H, W, C)), 'wqkv': _w((lambda *s: torch.randn(*s, dtype=torch.bfloat16) * 0.4)(C, 3 * C)), 'wo': _w((lambda *s: torch.randn(*s, dtype=torch.bfloat16) * 0.05)(C, C))}

def reference(x, wqkv, wo):
    B, H, W, C = x.shape
    win = 7
    nh, nw = (H // win, W // win)
    xw = (lambda x, *d: x.permute(*d))(x.reshape(B, nh, win, nw, win, C), 0, 1, 3, 2, 4, 5)
    xw = xw.reshape(B * nh * nw, win * win, C)
    qkv = xw @ wqkv
    q, k, v = (qkv[..., :C].clone(), qkv[..., C:2 * C].clone(), qkv[..., 2 * C:].clone())
    scale = C ** (-0.5)
    p = _softmax(torch.einsum('bqc,bkc->bqk', q, k) * scale, axis=-1)
    o = torch.einsum('bqk,bkc->bqc', p, v) @ wo
    o = (lambda x, *d: x.permute(*d))(o.reshape(B, nh, nw, win, win, C), 0, 1, 3, 2, 4, 5)
    return o.reshape(B, H, W, C)
```

```asm
; @launch grid=(254,1,1) block=(512,1,1) lds=163840
.amdgcn_target "amdgcn-amd-amdhsa--gfx950"
.text
.globl standalone__swin_window_attn__vision_kernel
.p2align 8
.type standalone__swin_window_attn__vision_kernel,@function
standalone__swin_window_attn__vision_kernel:
K0:
    s_cmp_ge_u32 s2, 254
    s_cbranch_scc1 L_end
    s_load_dwordx4 s[4:7], s[0:1], 0
    s_load_dwordx4 s[24:27], s[0:1], 16
    s_getpc_b64 s[48:49]
L_pc:
    s_lshr_b32 s41, s2, 3
    s_mul_i32 s42, s41, 0x80
    s_lshr_b32 s42, s42, 11
    s_mul_i32 s42, s42, 16
    s_sub_u32 s41, s41, s42
    s_mul_i32 s41, s41, 0x800
    v_lshrrev_b32 v1, 6, v0
    v_mul_u32_u24 v1, 62, v1
    v_sub_u32 v1, v0, v1
    v_lshl_add_u32 v1, v1, 7, s41
    v_min_u32 v1, K_end-L_pc-4, v1
    s_mov_b64 exec, 0x3
    global_load_dword v183, v1, s[48:49]
    s_mov_b64 exec, -1
    v_lshrrev_b32 v4, 6, v0
    v_mov_b32 v151, 0x27ff0
    v_readfirstlane_b32 s3, v4
    v_mov_b32 v2, 0
    v_mov_b32 v3, 0
    ds_write_b64 v151, v[2:3] offset:0
    ds_write_b64 v151, v[2:3] offset:8
    v_mov_b32 v5, 0x24300
    ds_write_b64 v5, v[2:3] offset:0
    v_and_b32 v157, 63, v0
    s_mov_b32 s45, 0x17a00
    s_and_b32 s43, s2, 7
    s_lshr_b32 s44, s2, 3
    s_mul_i32 s29, s43, 32
    s_add_u32 s29, s29, s44
    s_cmp_eq_u32 s43, 7
    s_subb_u32 s29, s29, 0
    s_add_u32 s100, s29, 0x2f7
    s_mul_i32 s29, s29, 3
    s_mov_b32 s39, 0
    s_cmp_ge_u32 s3, 4
    s_subb_u32 s47, s3, 0
    s_mov_b32 s30, s47
    s_mov_b32 s55, 0x240
    s_mov_b32 s18, 0xd800
    s_mov_b32 s22, 0x4800
    s_mov_b32 s19, 0x20000
    s_mov_b32 s23, 0x20000
    s_mov_b32 s11, 0x20000
    s_mov_b32 s15, 0x20000
    s_mov_b32 s14, 0x2fd00c0
    s_mul_i32 s43, s39, 0x6f2
    s_add_u32 s43, s43, s29
    s_add_u32 s43, s43, s30
    s_cmp_ge_u32 s30, 3
    s_cselect_b32 s41, s100, 0
    s_add_u32 s43, s43, s41
    s_and_b32 s44, s39, 1
    s_mul_i32 s44, s44, 7
    s_add_u32 s44, s44, s30
    s_mul_i32 m0, s44, 0x24c0
    s_mul_i32 s41, s43, 0xe071
    s_lshr_b32 s41, s41, 22
    s_mul_i32 s41, s41, 0x8fb80
    s_mul_i32 s42, s43, 0x540
    s_add_u32 s31, s41, s42
    s_cmp_lt_u32 s43, 5329
    s_cselect_b32 s10, 0x2fd00c0, 0
    s_mov_b32 s50, m0
    s_cmp_lt_u32 s3, 4
    s_cbranch_scc1 L_early
    s_mov_b32 s46, 1
    s_setprio 2
    v_add_u32 v136, -256, v0
    v_mul_u32_u24 v137, 0xaab, v136
    v_lshrrev_b32 v137, 16, v137
    v_mul_u32_u24 v138, 24, v137
    v_sub_u32 v138, v136, v138
    v_lshrrev_b32 v139, 2, v137
    v_and_b32 v139, 4, v139
    v_and_or_b32 v139, v137, 2, v139
    v_xor_b32 v138, v138, v139
    v_lshlrev_b32 v138, 4, v138
    v_mad_u32_u24 v152, v137, s55, v138
    v_add_u32 v136, 0, v0
    v_mul_u32_u24 v137, 0xaab, v136
    v_lshrrev_b32 v137, 16, v137
    v_mul_u32_u24 v138, 24, v137
    v_sub_u32 v138, v136, v138
    v_lshrrev_b32 v139, 2, v137
    v_and_b32 v139, 4, v139
    v_and_or_b32 v139, v137, 2, v139
    v_xor_b32 v138, v138, v139
    v_lshlrev_b32 v138, 4, v138
    v_mad_u32_u24 v153, v137, s55, v138
    v_add_u32 v136, 0x100, v0
    v_mul_u32_u24 v137, 0xaab, v136
    v_lshrrev_b32 v137, 16, v137
    v_mul_u32_u24 v138, 24, v137
    v_sub_u32 v138, v136, v138
    v_lshrrev_b32 v139, 2, v137
    v_and_b32 v139, 4, v139
    v_and_or_b32 v139, v137, 2, v139
    v_xor_b32 v138, v138, v139
    v_lshlrev_b32 v138, 4, v138
    v_mad_u32_u24 v154, v137, s55, v138
    s_lshl_b32 s51, s3, 10
    s_add_u32 s51, s51, 0xf140
    s_mov_b32 s53, 0
    s_mov_b32 s54, 0x4800
    v_lshlrev_b32 v156, 4, v157
    v_add_u32 v5, -256, v0
    v_mul_u32_u24 v4, 0xab, v5
    v_lshrrev_b32 v4, 11, v4
    v_mul_u32_u24 v6, 12, v4
    v_sub_u32 v5, v5, v6
    v_lshlrev_b32 v5, 4, v5
    v_min_u32 v4, 20, v4
    v_add_u32 v6, s29, v4
    v_mul_u32_u24 v7, 37, v4
    v_lshrrev_b32 v7, 8, v7
    v_mul_u32_u24 v8, 7, v7
    v_sub_u32 v8, v4, v8
    v_cmp_le_u32 vcc, 3, v8
    v_add_u32 v8, s100, v6
    s_nop 0
    v_cndmask_b32 v6, v6, v8, vcc
    v_mul_u32_u24 v7, 0x6eb, v7
    v_add_u32 v6, v6, v7
    v_mul_u32_u24 v7, 0xe071, v6
    v_lshrrev_b32 v7, 22, v7
    v_mul_u32_u24 v7, 0x8fb80, v7
    v_mul_u32_u24 v6, 0x540, v6
    v_add3_u32 v6, v6, v7, v5
    v_add_u32 v6, 0x90000, v6
    s_waitcnt lgkmcnt(0)
    s_mov_b32 s16, s6
    s_and_b32 s17, s7, 0xffff
    s_mov_b32 s8, s4
    s_and_b32 s9, s5, 0xffff
    s_mov_b32 s20, s24
    s_and_b32 s21, s25, 0xffff
    s_mov_b32 s12, s26
    s_and_b32 s13, s27, 0xffff
    s_mov_b32 m0, s51
    s_add_u32 s51, s51, 0x1000
    buffer_load_dwordx4 v152, s[16:19], s53 offen  lds
    s_mov_b32 m0, s51
    s_add_u32 s51, s51, 0x1000
    buffer_load_dwordx4 v153, s[16:19], s53 offen  lds
    s_mov_b32 m0, s51
    s_add_u32 s51, s51, 0x1000
    buffer_load_dwordx4 v154, s[16:19], s53 offen  lds
    s_add_u32 s53, s53, s54
    s_mov_b32 m0, s51
    s_add_u32 s51, s51, 0x1000
    buffer_load_dwordx4 v152, s[16:19], s53 offen  lds
    s_mov_b32 m0, s51
    s_add_u32 s51, s51, 0x1000
    buffer_load_dwordx4 v153, s[16:19], s53 offen  lds
    s_mov_b32 m0, s51
    s_add_u32 s51, s51, 0x1000
    buffer_load_dwordx4 v154, s[16:19], s53 offen  lds
    s_add_u32 s53, s53, s54
    s_mov_b32 m0, s51
    s_add_u32 s51, s51, 0x1000
    buffer_load_dwordx4 v152, s[16:19], s53 offen  lds
    s_mov_b32 m0, s51
    s_add_u32 s51, s51, 0x1000
    buffer_load_dwordx4 v153, s[16:19], s53 offen  lds
    s_mov_b32 m0, s51
    s_add_u32 s51, s51, 0x1000
    buffer_load_dwordx4 v154, s[16:19], s53 offen  lds
    s_add_u32 s53, s53, s54
    s_lshl_b32 s41, s3, 10
    s_add_u32 m0, s41, 0x21350
    s_nop 0
    buffer_load_dwordx4 v6, s[8:11], 0 offen  lds
    s_branch L_late2
L_early:
    s_mov_b32 s46, 0
    v_mul_u32_u24 v137, 0xab, v157
    v_lshrrev_b32 v137, 11, v137
    v_mul_u32_u24 v138, 12, v137
    v_sub_u32 v138, v157, v138
    v_lshrrev_b32 v141, 2, v137
    v_and_b32 v139, 3, v137
    v_lshl_add_u32 v139, v139, 2, v141
    v_sub_u32 v141, 0, v141
    v_and_b32 v141, 3, v141
    v_xor_b32 v138, v138, v141
    v_lshlrev_b32 v138, 4, v138
    v_mad_u32_u24 v152, v137, s55, v138
    v_mul_u32_u24 v132, 0xc0, v137
    v_add_u32 v132, v132, v138
    v_mul_u32_u24 v140, 0xc0, v139
    v_add_u32 v140, v138, v140
    v_mul_u32_u24 v139, 37, v139
    v_lshrrev_b32 v141, 8, v139
    v_mad_u32_u24 v160, v141, s45, v140
    v_add_u32 v139, 0x250, v139
    v_add_u32 v140, 0xc00, v140
    v_lshrrev_b32 v141, 8, v139
    v_mad_u32_u24 v163, v141, s45, v140
    v_add_u32 v139, 0x250, v139
    v_add_u32 v140, 0xc00, v140
    v_lshrrev_b32 v141, 8, v139
    v_mad_u32_u24 v166, v141, s45, v140
    s_waitcnt lgkmcnt(0)
    s_mov_b32 s16, s6
    s_and_b32 s17, s7, 0xffff
    s_mov_b32 s8, s4
    s_and_b32 s9, s5, 0xffff
    s_mov_b32 s20, s24
    s_and_b32 s21, s25, 0xffff
    s_mov_b32 s12, s26
    s_and_b32 s13, s27, 0xffff
    s_cmp_eq_u32 s3, 3
    s_cbranch_scc1 L_xload
    s_add_u32 m0, s50, 0
    s_nop 0
    buffer_load_dwordx4 v160, s[8:11], s31 offen  lds
    s_add_u32 m0, s50, 0xc00
    s_nop 0
    buffer_load_dwordx4 v163, s[8:11], s31 offen  lds
    s_add_u32 m0, s50, 0x1800
    s_nop 0
    buffer_load_dwordx4 v166, s[8:11], s31 offen  lds
    v_add_u32 v136, 64, v157
    v_mul_u32_u24 v137, 0xab, v136
    v_lshrrev_b32 v137, 11, v137
    v_mul_u32_u24 v138, 12, v137
    v_sub_u32 v138, v136, v138
    v_lshrrev_b32 v141, 2, v137
    v_and_b32 v139, 3, v137
    v_lshl_add_u32 v139, v139, 2, v141
    v_sub_u32 v141, 0, v141
    v_and_b32 v141, 3, v141
    v_xor_b32 v138, v138, v141
    v_lshlrev_b32 v138, 4, v138
    v_mul_u32_u24 v140, 0xc0, v139
    v_add_u32 v140, v138, v140
    v_mul_u32_u24 v139, 37, v139
    v_lshrrev_b32 v141, 8, v139
    v_mad_u32_u24 v161, v141, s45, v140
    v_add_u32 v139, 0x250, v139
    v_add_u32 v140, 0xc00, v140
    v_lshrrev_b32 v141, 8, v139
    v_mad_u32_u24 v164, v141, s45, v140
    v_add_u32 v139, 0x250, v139
    v_add_u32 v140, 0xc00, v140
    v_lshrrev_b32 v141, 8, v139
    v_mad_u32_u24 v167, v141, s45, v140
    s_add_u32 m0, s50, 0x400
    s_nop 0
    buffer_load_dwordx4 v161, s[8:11], s31 offen  lds
    s_add_u32 m0, s50, 0x1000
    s_nop 0
    buffer_load_dwordx4 v164, s[8:11], s31 offen  lds
    s_add_u32 m0, s50, 0x1c00
    s_nop 0
    buffer_load_dwordx4 v167, s[8:11], s31 offen  lds
    v_add_u32 v136, 0x80, v157
    v_mul_u32_u24 v137, 0xab, v136
    v_lshrrev_b32 v137, 11, v137
    v_mul_u32_u24 v138, 12, v137
    v_sub_u32 v138, v136, v138
    v_lshrrev_b32 v141, 2, v137
    v_and_b32 v139, 3, v137
    v_lshl_add_u32 v139, v139, 2, v141
    v_sub_u32 v141, 0, v141
    v_and_b32 v141, 3, v141
    v_xor_b32 v138, v138, v141
    v_lshlrev_b32 v138, 4, v138
    v_mul_u32_u24 v140, 0xc0, v139
    v_add_u32 v140, v138, v140
    v_mul_u32_u24 v139, 37, v139
    v_lshrrev_b32 v141, 8, v139
    v_mad_u32_u24 v162, v141, s45, v140
    v_add_u32 v139, 0x250, v139
    v_add_u32 v140, 0xc00, v140
    v_lshrrev_b32 v141, 8, v139
    v_mad_u32_u24 v165, v141, s45, v140
    v_add_u32 v139, 0x250, v139
    v_add_u32 v140, 0xc00, v140
    v_lshrrev_b32 v141, 8, v139
    v_mad_u32_u24 v168, v141, s45, v140
    v_lshlrev_b32 v156, 4, v157
    v_add_u32 v169, 0x90000, v156
    s_barrier
    s_add_u32 m0, s50, 0x800
    s_nop 0
    buffer_load_dwordx4 v162, s[8:11], s31 offen  lds
    s_add_u32 m0, s50, 0x1400
    s_nop 0
    buffer_load_dwordx4 v165, s[8:11], s31 offen  lds
    s_add_u32 m0, s50, 0x2000
    s_nop 0
    buffer_load_dwordx4 v168, s[8:11], s31 offen  lds
    s_add_u32 m0, s50, 0x2400
    s_mov_b64 exec, 0xfff
    buffer_load_dwordx4 v169, s[8:11], s31 offen  lds
    s_mov_b64 exec, -1
    v_and_b32 v158, 15, v157
    v_lshrrev_b32 v159, 4, v157
    s_mul_i32 s41, s47, 0x24c0
    s_mul_i32 s43, s47, 0xc0
    s_cmp_lg_u32 s3, 3
    s_cselect_b32 s41, s41, 0
    s_add_u32 s42, s41, 0x2400
    v_lshrrev_b32 v136, 2, v158
    v_sub_u32 v137, 0, v136
    v_and_b32 v137, 3, v137
    v_xor_b32 v137, v137, v159
    v_mul_u32_u24 v138, 0xc0, v158
    v_lshl_add_u32 v146, v137, 4, v138
    v_add_u32 v170, s41, v146
    v_lshlrev_b32 v139, 4, v159
    s_mul_i32 s44, s47, 0x190
    s_add_u32 s44, s44, 0x20280
    v_add_u32 v171, s44, v139
    v_cmp_eq_u32 vcc, 1, v158
    v_add_u32 v140, 0xc0, v171
    s_add_u32 s44, s43, 0x22350
    v_cndmask_b32 v171, v171, v140, vcc
    v_lshl_add_u32 v182, v158, 2, s44
    v_mov_b32 v181, 0
    v_lshl_add_u32 v140, v159, 2, v136
    v_mul_u32_u24 v140, 0xc0, v140
    v_sub_u32 v141, 0, v159
    v_and_b32 v141, 3, v141
    v_bfe_u32 v142, v158, 1, 1
    v_xor_b32 v141, v141, v142
    v_lshl_add_u32 v140, v141, 4, v140
    v_and_b32 v142, 1, v158
    v_lshl_add_u32 v140, v142, 3, v140
    v_add_u32 v172, s41, v140
    v_xor_b32 v173, 32, v172
    v_and_b32 v142, 3, v158
    v_lshlrev_b32 v145, 3, v142
    v_add_u32 v174, s42, v145
    v_mul_u32_u24 v143, 12, v158
    v_mul_u32_u24 v144, 0xc0, v159
    v_add_u32 v179, v143, v144
    v_add_u32 v144, 0x17a00, v179
    v_mov_b32 v137, 0xff800000
    v_cmp_le_u32 vcc, 1, v159
    v_add_u32 v175, 0x23700, v156
    v_mov_b32 v150, 1
    v_cndmask_b32 v176, v179, v144, vcc
    v_cndmask_b32 v180, 0, v137, vcc
    v_cmp_le_u32 vcc, 2, v159
    v_mov_b32 v54, 0x27ff0
    s_nop 0
    v_cndmask_b32 v177, v179, v144, vcc
    v_cmp_le_u32 vcc, 3, v159
    s_bfe_u32 s43, s3, 0x10001
    s_and_b32 s44, s3, 1
    v_cndmask_b32 v178, v179, v144, vcc
    s_and_b32 s59, s3, 3
    s_lshl_b32 s59, s59, 3
    s_bfe_u32 s41, s2, 0x30003
    s_add_u32 s59, s59, s41
    s_lshl_b32 s59, s59, 10
    s_sub_u32 s59, s59, 0x11b800
    s_mov_b32 s28, 0
    s_mov_b32 s40, 0x10140
    s_mov_b32 s58, 0x540
    s_add_u32 s30, s47, 4
L_pollb:
    ds_read_b32 v55, v151 offset:4
    s_waitcnt lgkmcnt(0)
    v_readfirstlane_b32 s41, v55
    s_nop 0
    s_cmp_lt_u32 s41, 4
    s_cbranch_scc1 L_pollb
    ds_read_b128 v[184:187], v175 offset:0
    ds_read_b128 v[188:191], v175 offset:1024
    ds_read_b128 v[192:195], v175 offset:2048
    ds_read_b128 v[196:199], v175 offset:3120
    ds_read_b128 v[200:203], v175 offset:4144
    ds_read_b128 v[204:207], v175 offset:5168
    ds_read_b128 v[208:211], v175 offset:6240
    ds_read_b128 v[212:215], v175 offset:7264
    ds_read_b128 v[216:219], v175 offset:8288
    ds_read_b128 v[220:223], v175 offset:9360
    ds_read_b128 v[224:227], v175 offset:10384
    ds_read_b128 v[228:231], v175 offset:11408
    ds_read_b128 v[232:235], v175 offset:12480
    ds_read_b128 v[236:239], v175 offset:13504
    ds_read_b128 v[240:243], v175 offset:14528
    ds_read_b128 v[244:247], v175 offset:15600
    ds_read_b128 v[248:251], v175 offset:16624
    ds_read_b128 v[252:255], v175 offset:17648
    s_waitcnt lgkmcnt(0)
    s_mov_b64 exec, 1
    ds_add_u32 v151, v150 offset:8
    s_mov_b64 exec, -1
    s_waitcnt vmcnt(0)
L_A0:
    s_setprio 1
    s_mov_b32 s14, 0
    s_mov_b32 s32, 0
    s_mov_b32 s33, 0
    s_mov_b32 s34, 0
    s_mov_b32 s35, 0
    s_mov_b32 s36, 0
    s_mov_b32 s37, 0
    s_mov_b32 s38, 0
    s_mov_b64 vcc, 0
    ds_read_b128 v[84:87], v170 offset:0
    ds_read_b128 v[88:91], v170 offset:64
    ds_read_b128 v[92:95], v170 offset:128
    ds_read_b128 v[96:99], v170 offset:3072
    ds_read_b128 v[100:103], v170 offset:3136
    ds_read_b128 v[104:107], v170 offset:3200
    ds_read_b128 v[120:123], v170 offset:6144
    ds_read_b128 v[124:127], v170 offset:6208
    ds_read_b128 v[128:131], v170 offset:6272
    s_waitcnt lgkmcnt(8)
    v_mfma_f32_16x16x32_bf16 v[108:111], v[184:187], v[84:87], 0
    s_waitcnt lgkmcnt(7)
    v_mfma_f32_16x16x32_bf16 v[108:111], v[188:191], v[88:91], v[108:111]
    s_waitcnt lgkmcnt(6)
    v_mfma_f32_16x16x32_bf16 v[108:111], v[192:195], v[92:95], v[108:111]
    v_mfma_f32_16x16x32_bf16 v[16:19], v[196:199], v[84:87], 0
    v_mfma_f32_16x16x32_bf16 v[16:19], v[200:203], v[88:91], v[16:19]
    v_mfma_f32_16x16x32_bf16 v[16:19], v[204:207], v[92:95], v[16:19]
    v_mfma_f32_16x16x32_bf16 v[112:115], v[208:211], v[84:87], 0
    v_mfma_f32_16x16x32_bf16 v[112:115], v[212:215], v[88:91], v[112:115]
    v_mfma_f32_16x16x32_bf16 v[112:115], v[216:219], v[92:95], v[112:115]
    v_mfma_f32_16x16x32_bf16 v[20:23], v[220:223], v[84:87], 0
    v_mfma_f32_16x16x32_bf16 v[20:23], v[224:227], v[88:91], v[20:23]
    v_cvt_pk_bf16_f32 v108, v108, v109
    v_cvt_pk_bf16_f32 v109, v110, v111
    v_mfma_f32_16x16x32_bf16 v[20:23], v[228:231], v[92:95], v[20:23]
    v_cvt_pk_bf16_f32 v110, v16, v17
    v_cvt_pk_bf16_f32 v111, v18, v19
    v_mfma_f32_16x16x32_bf16 v[116:119], v[232:235], v[84:87], 0
    v_cvt_pk_bf16_f32 v112, v112, v113
    v_cvt_pk_bf16_f32 v113, v114, v115
    v_mfma_f32_16x16x32_bf16 v[116:119], v[236:239], v[88:91], v[116:119]
    v_mfma_f32_16x16x32_bf16 v[116:119], v[240:243], v[92:95], v[116:119]
    v_mfma_f32_16x16x32_bf16 v[24:27], v[244:247], v[84:87], 0
    v_cvt_pk_bf16_f32 v114, v20, v21
    v_cvt_pk_bf16_f32 v115, v22, v23
    v_mfma_f32_16x16x32_bf16 v[24:27], v[248:251], v[88:91], v[24:27]
    v_mfma_f32_16x16x32_bf16 v[24:27], v[252:255], v[92:95], v[24:27]
    s_waitcnt lgkmcnt(5)
    v_mfma_f32_16x16x32_bf16 v[132:135], v[184:187], v[96:99], 0
    s_waitcnt lgkmcnt(4)
    v_mfma_f32_16x16x32_bf16 v[132:135], v[188:191], v[100:103], v[132:135]
    s_waitcnt lgkmcnt(3)
    v_mfma_f32_16x16x32_bf16 v[132:135], v[192:195], v[104:107], v[132:135]
    v_cvt_pk_bf16_f32 v116, v116, v117
    v_cvt_pk_bf16_f32 v117, v118, v119
    v_mfma_f32_16x16x32_bf16 v[60:63], v[196:199], v[96:99], 0
    v_mfma_f32_16x16x32_bf16 v[60:63], v[200:203], v[100:103], v[60:63]
    v_mfma_f32_16x16x32_bf16 v[60:63], v[204:207], v[104:107], v[60:63]
    v_cvt_pk_bf16_f32 v118, v24, v25
    v_cvt_pk_bf16_f32 v119, v26, v27
    v_mfma_f32_16x16x32_bf16 v[136:139], v[208:211], v[96:99], 0
    v_cvt_pk_bf16_f32 v132, v132, v133
    v_cvt_pk_bf16_f32 v133, v134, v135
    v_mfma_f32_16x16x32_bf16 v[136:139], v[212:215], v[100:103], v[136:139]
    v_mfma_f32_16x16x32_bf16 v[136:139], v[216:219], v[104:107], v[136:139]
    v_mfma_f32_16x16x32_bf16 v[64:67], v[220:223], v[96:99], 0
    v_cvt_pk_bf16_f32 v134, v60, v61
    v_cvt_pk_bf16_f32 v135, v62, v63
    v_mfma_f32_16x16x32_bf16 v[64:67], v[224:227], v[100:103], v[64:67]
    v_mfma_f32_16x16x32_bf16 v[64:67], v[228:231], v[104:107], v[64:67]
    v_mfma_f32_16x16x32_bf16 v[140:143], v[232:235], v[96:99], 0
    v_mfma_f32_16x16x32_bf16 v[140:143], v[236:239], v[100:103], v[140:143]
    v_mfma_f32_16x16x32_bf16 v[140:143], v[240:243], v[104:107], v[140:143]
    v_cvt_pk_bf16_f32 v136, v136, v137
    v_cvt_pk_bf16_f32 v137, v138, v139
    v_mfma_f32_16x16x32_bf16 v[68:71], v[244:247], v[96:99], 0
    v_mfma_f32_16x16x32_bf16 v[68:71], v[248:251], v[100:103], v[68:71]
    v_mfma_f32_16x16x32_bf16 v[68:71], v[252:255], v[104:107], v[68:71]
    v_cvt_pk_bf16_f32 v138, v64, v65
    v_cvt_pk_bf16_f32 v139, v66, v67
    v_mfma_f32_16x16x32_bf16 v[0:3], v[84:87], v[108:111], 0
    v_cvt_pk_bf16_f32 v140, v140, v141
    v_cvt_pk_bf16_f32 v141, v142, v143
    v_mfma_f32_16x16x32_bf16 v[0:3], v[88:91], v[112:115], v[0:3]
    v_mfma_f32_16x16x32_bf16 v[0:3], v[92:95], v[116:119], v[0:3]
    v_mfma_f32_16x16x32_bf16 v[4:7], v[96:99], v[108:111], 0
    v_cvt_pk_bf16_f32 v142, v68, v69
    v_cvt_pk_bf16_f32 v143, v70, v71
    v_mfma_f32_16x16x32_bf16 v[4:7], v[100:103], v[112:115], v[4:7]
    v_mfma_f32_16x16x32_bf16 v[4:7], v[104:107], v[116:119], v[4:7]
    s_waitcnt lgkmcnt(2)
    v_mfma_f32_16x16x32_bf16 v[8:11], v[120:123], v[108:111], 0
    s_waitcnt lgkmcnt(1)
    v_mfma_f32_16x16x32_bf16 v[8:11], v[124:127], v[112:115], v[8:11]
    s_waitcnt lgkmcnt(0)
    v_mfma_f32_16x16x32_bf16 v[8:11], v[128:131], v[116:119], v[8:11]
    v_mfma_f32_16x16x32_bf16 v[108:111], v[184:187], v[120:123], 0
    v_mfma_f32_16x16x32_bf16 v[108:111], v[188:191], v[124:127], v[108:111]
    v_mfma_f32_16x16x32_bf16 v[108:111], v[192:195], v[128:131], v[108:111]
    v_mfma_f32_16x16x32_bf16 v[16:19], v[196:199], v[120:123], 0
    v_mfma_f32_16x16x32_bf16 v[16:19], v[200:203], v[124:127], v[16:19]
    v_mfma_f32_16x16x32_bf16 v[16:19], v[204:207], v[128:131], v[16:19]
    v_mfma_f32_16x16x32_bf16 v[112:115], v[208:211], v[120:123], 0
    v_mfma_f32_16x16x32_bf16 v[112:115], v[212:215], v[124:127], v[112:115]
    v_mfma_f32_16x16x32_bf16 v[112:115], v[216:219], v[128:131], v[112:115]
    v_mfma_f32_16x16x32_bf16 v[20:23], v[220:223], v[120:123], 0
    v_mfma_f32_16x16x32_bf16 v[20:23], v[224:227], v[124:127], v[20:23]
    v_cvt_pk_bf16_f32 v108, v108, v109
    v_cvt_pk_bf16_f32 v109, v110, v111
    v_mfma_f32_16x16x32_bf16 v[20:23], v[228:231], v[128:131], v[20:23]
    v_cvt_pk_bf16_f32 v110, v16, v17
    v_cvt_pk_bf16_f32 v111, v18, v19
    v_mfma_f32_16x16x32_bf16 v[116:119], v[232:235], v[120:123], 0
    v_cvt_pk_bf16_f32 v112, v112, v113
    v_cvt_pk_bf16_f32 v113, v114, v115
    v_mfma_f32_16x16x32_bf16 v[116:119], v[236:239], v[124:127], v[116:119]
    v_mfma_f32_16x16x32_bf16 v[116:119], v[240:243], v[128:131], v[116:119]
    v_mfma_f32_16x16x32_bf16 v[24:27], v[244:247], v[120:123], 0
    v_cvt_pk_bf16_f32 v114, v20, v21
    v_cvt_pk_bf16_f32 v115, v22, v23
    v_mfma_f32_16x16x32_bf16 v[24:27], v[248:251], v[124:127], v[24:27]
    v_mfma_f32_16x16x32_bf16 v[24:27], v[252:255], v[128:131], v[24:27]
    s_nop 2
    v_cvt_pk_bf16_f32 v116, v116, v117
    v_cvt_pk_bf16_f32 v117, v118, v119
    s_nop 2
    v_cvt_pk_bf16_f32 v118, v24, v25
    v_cvt_pk_bf16_f32 v119, v26, v27
    s_waitcnt lgkmcnt(0)
    s_cmp_eq_u32 s46, 1
    s_cbranch_scc1 L_A0b
L_pollt:
    ds_read_b32 v55, v54 offset:12
    s_waitcnt lgkmcnt(0)
    v_readfirstlane_b32 s41, v55
    s_nop 0
    s_cmp_lt_u32 s41, 4
    s_cbranch_scc1 L_pollt
L_A0b:
    s_nop 1
    v_mfma_f32_16x16x32_bf16 v[16:19], v[84:87], v[132:135], 0
    ds_read_b128 v[72:75], v171 offset:0
    v_mfma_f32_16x16x32_bf16 v[16:19], v[88:91], v[136:139], v[16:19]
    ds_read_b128 v[76:79], v171 offset:64
    v_mfma_f32_16x16x32_bf16 v[16:19], v[92:95], v[140:143], v[16:19]
    ds_read_b128 v[80:83], v171 offset:128
    v_mfma_f32_16x16x32_bf16 v[20:23], v[96:99], v[132:135], 0
    ds_read_b64_tr_b16 v[60:61], v172 offset:0
    v_mfma_f32_16x16x32_bf16 v[20:23], v[100:103], v[136:139], v[20:23]
    ds_read_b64_tr_b16 v[62:63], v172 offset:3072
    v_mfma_f32_16x16x32_bf16 v[20:23], v[104:107], v[140:143], v[20:23]
    ds_read_b64_tr_b16 v[64:65], v172 offset:6144
    v_mfma_f32_16x16x32_bf16 v[24:27], v[120:123], v[132:135], 0
    ds_read_b64_tr_b16 v[66:67], v174 offset:0
    v_mfma_f32_16x16x32_bf16 v[24:27], v[124:127], v[136:139], v[24:27]
    ds_read_b64_tr_b16 v[68:69], v173 offset:0
    v_mfma_f32_16x16x32_bf16 v[24:27], v[128:131], v[140:143], v[24:27]
    ds_read_b64_tr_b16 v[70:71], v173 offset:3072
    s_waitcnt lgkmcnt(8)
    v_mfma_f32_16x16x32_bf16 v[12:15], v[72:75], v[84:87], v[180:183]
    s_waitcnt lgkmcnt(7)
    v_mfma_f32_16x16x32_bf16 v[12:15], v[76:79], v[88:91], v[12:15]
    s_waitcnt lgkmcnt(6)
    v_mfma_f32_16x16x32_bf16 v[12:15], v[80:83], v[92:95], v[12:15]
    v_mfma_f32_16x16x32_bf16 v[28:31], v[72:75], v[96:99], v[180:183]
    v_mfma_f32_16x16x32_bf16 v[28:31], v[76:79], v[100:103], v[28:31]
    v_mfma_f32_16x16x32_bf16 v[28:31], v[80:83], v[104:107], v[28:31]
    v_mfma_f32_16x16x32_bf16 v[44:47], v[72:75], v[120:123], v[180:183]
    ds_read_b64_tr_b16 v[72:73], v173 offset:6144
    v_mfma_f32_16x16x32_bf16 v[44:47], v[76:79], v[124:127], v[44:47]
    ds_read_b64_tr_b16 v[74:75], v174 offset:32
    v_mfma_f32_16x16x32_bf16 v[44:47], v[80:83], v[128:131], v[44:47]
    ds_read_b64_tr_b16 v[76:77], v172 offset:64
    v_mfma_f32_16x16x32_bf16 v[32:35], v[84:87], v[108:111], 0
    ds_read_b64_tr_b16 v[78:79], v172 offset:3136
    v_mfma_f32_16x16x32_bf16 v[32:35], v[88:91], v[112:115], v[32:35]
    ds_read_b64_tr_b16 v[80:81], v172 offset:6208
    v_mfma_f32_16x16x32_bf16 v[32:35], v[92:95], v[116:119], v[32:35]
    ds_read_b64_tr_b16 v[82:83], v174 offset:64
    v_mfma_f32_16x16x32_bf16 v[36:39], v[96:99], v[108:111], 0
    v_mfma_f32_16x16x32_bf16 v[36:39], v[100:103], v[112:115], v[36:39]
    s_mov_b64 exec, 0xffff
    ds_write_b32 v182, v13 offset:0
    v_mfma_f32_16x16x32_bf16 v[36:39], v[104:107], v[116:119], v[36:39]
    ds_write_b32 v182, v29 offset:64
    v_mfma_f32_16x16x32_bf16 v[40:43], v[120:123], v[108:111], 0
    ds_write_b32 v182, v45 offset:128
    v_mfma_f32_16x16x32_bf16 v[40:43], v[124:127], v[112:115], v[40:43]
    s_mov_b64 exec, -1
    v_mfma_f32_16x16x32_bf16 v[40:43], v[128:131], v[116:119], v[40:43]
    ds_read_b64_tr_b16 v[84:85], v173 offset:64
    ds_read_b64_tr_b16 v[86:87], v173 offset:3136
    ds_read_b64_tr_b16 v[88:89], v173 offset:6208
    ds_read_b64_tr_b16 v[90:91], v174 offset:96
    ds_read_b64_tr_b16 v[92:93], v172 offset:128
    ds_read_b64_tr_b16 v[94:95], v172 offset:3200
    ds_read_b64_tr_b16 v[96:97], v172 offset:6272
    ds_read_b64_tr_b16 v[98:99], v174 offset:128
    ds_read_b64_tr_b16 v[100:101], v173 offset:128
    ds_read_b64_tr_b16 v[102:103], v173 offset:3200
    ds_read_b64_tr_b16 v[104:105], v173 offset:6272
    ds_read_b64_tr_b16 v[106:107], v174 offset:160
    s_waitcnt lgkmcnt(12)
L_loop:
    s_lshl_b32 s41, s46, 2
    s_add_u32 s41, s41, s28
    s_setprio 0
    s_cmp_eq_u32 s28, 0
    s_cselect_b64 vcc, -1, 0
    s_barrier
L_sm:
    s_nop 3
    v_max3_f32 v108, v0, v1, v2
    v_max3_f32 v109, v3, v4, v5
    v_max3_f32 v110, v6, v7, v8
    v_max3_f32 v111, v9, v10, v11
    s_cbranch_vccnz L_ds0
    buffer_store_dwordx3 v[48:50], v179, s[12:15], s34 offen offset:384 sc1
L_ds0:
    v_max3_f32 v108, v108, v109, v12
    v_max3_f32 v13, v108, v110, v111
    v_max3_f32 v112, v16, v17, v18
    v_max3_f32 v113, v19, v20, v21
    v_max3_f32 v114, v22, v23, v24
    v_max3_f32 v115, v25, v26, v27
    s_cbranch_vccnz L_ds1
    buffer_store_dwordx3 v[52:54], v176, s[12:15], s34 offen offset:1152 sc1
L_ds1:
    v_max3_f32 v112, v112, v113, v28
    v_max3_f32 v29, v112, v114, v115
    v_max3_f32 v116, v32, v33, v34
    v_max3_f32 v117, v35, v36, v37
    v_max3_f32 v118, v38, v39, v40
    v_max3_f32 v119, v41, v42, v43
    s_cbranch_vccnz L_ds2
    buffer_store_dwordx3 v[56:58], v179, s[12:15], s35 offen offset:576 sc1
L_ds2:
    v_max3_f32 v116, v116, v117, v44
    v_max3_f32 v45, v116, v118, v119
    v_mov_b32 v14, v45
    v_permlane32_swap_b32 v13, v29
    s_cbranch_vccnz L_ds3
    buffer_store_dwordx3 v[160:162], v179, s[12:15], s36 offen offset:0 sc1
L_ds3:
    v_max_f32 v13, v13, v29
    v_permlane32_swap_b32 v45, v14
    v_max_f32 v45, v45, v14
    s_nop 1
    v_permlane16_swap_b32 v13, v45
    s_cbranch_vccnz L_ds4
    buffer_store_dwordx3 v[164:166], v178, s[12:15], s36 offen offset:768 sc1
L_ds4:
    v_max_f32 v13, v13, v45
    v_mov_b32 v45, v13
    s_nop 1
    v_permlane16_swap_b32 v13, v45
    v_mov_b32 v29, v13
    v_sub_f32 v32, v32, v45
    s_cbranch_vccnz L_ds5
    buffer_store_dwordx3 v[148:150], v179, s[12:15], s37 offen offset:192 sc1
L_ds5:
    v_sub_f32 v33, v33, v45
    v_permlane32_swap_b32 v13, v29
    v_sub_f32 v0, v0, v13
    v_sub_f32 v1, v1, v13
    s_cbranch_vccnz L_ds6
    buffer_store_dwordx3 v[152:154], v177, s[12:15], s37 offen offset:960 sc1
L_ds6:
    v_exp_f32 v0, v0
    v_exp_f32 v1, v1
    v_sub_f32 v2, v2, v13
    v_sub_f32 v3, v3, v13
    s_cbranch_vccnz L_ds7
    buffer_store_dwordx3 v[156:158], v179, s[12:15], s38 offen offset:384 sc1
L_ds7:
    v_exp_f32 v2, v2
    v_exp_f32 v3, v3
    v_sub_f32 v4, v4, v13
    v_sub_f32 v5, v5, v13
    v_exp_f32 v4, v4
    v_exp_f32 v5, v5
    v_sub_f32 v6, v6, v13
    v_sub_f32 v7, v7, v13
    v_exp_f32 v6, v6
    v_exp_f32 v7, v7
    v_sub_f32 v8, v8, v13
    v_sub_f32 v9, v9, v13
    v_exp_f32 v8, v8
    v_exp_f32 v9, v9
    v_sub_f32 v10, v10, v13
    v_sub_f32 v11, v11, v13
    v_exp_f32 v10, v10
    v_exp_f32 v11, v11
    v_sub_f32 v12, v12, v13
    v_exp_f32 v12, v12
    v_add_f32 v108, v0, v1
    v_add_f32 v109, v2, v3
    v_add_f32 v110, v4, v5
    v_add_f32 v111, v6, v7
    v_add_f32 v108, v108, v8
    v_add_f32 v109, v109, v9
    s_mul_i32 s39, s28, 7
    v_add_f32 v110, v110, v10
    v_add_f32 v111, v111, v11
    v_add_f32 v108, v108, v12
    v_add_f32 v110, v110, v111
    v_add_f32 v108, v108, v109
    v_add_f32 v13, v108, v110
    s_add_u32 s39, s39, s47
    v_sub_f32 v16, v16, v29
    v_sub_f32 v17, v17, v29
    v_exp_f32 v16, v16
    v_exp_f32 v17, v17
    s_add_u32 s39, s39, 8
    v_sub_f32 v18, v18, v29
    v_sub_f32 v19, v19, v29
    v_exp_f32 v18, v18
    v_exp_f32 v19, v19
    s_mul_i32 s43, s28, 0x6f2
    v_sub_f32 v20, v20, v29
    v_sub_f32 v21, v21, v29
    v_exp_f32 v20, v20
    v_exp_f32 v21, v21
    v_sub_f32 v22, v22, v29
    v_sub_f32 v23, v23, v29
    s_add_u32 s43, s43, s29
    v_exp_f32 v22, v22
    v_exp_f32 v23, v23
    v_sub_f32 v24, v24, v29
    v_sub_f32 v25, v25, v29
    s_add_u32 s43, s43, s47
    v_exp_f32 v24, v24
    v_exp_f32 v25, v25
    v_sub_f32 v26, v26, v29
    v_sub_f32 v27, v27, v29
    s_cmp_ge_u32 s47, 3
    v_exp_f32 v26, v26
    v_exp_f32 v27, v27
    v_sub_f32 v28, v28, v29
    s_cselect_b32 s41, s100, 0
    v_exp_f32 v28, v28
    v_add_f32 v112, v16, v17
    v_add_f32 v113, v18, v19
    v_add_f32 v114, v20, v21
    v_add_f32 v115, v22, v23
    v_add_f32 v112, v112, v24
    v_add_f32 v113, v113, v25
    s_add_u32 s43, s43, s41
    v_add_f32 v114, v114, v26
    v_add_f32 v115, v115, v27
    v_add_f32 v112, v112, v28
    v_add_f32 v114, v114, v115
    v_add_f32 v112, v112, v113
    v_add_f32 v29, v112, v114
    s_mul_i32 s41, s43, 0xe071
    v_exp_f32 v32, v32
    v_exp_f32 v33, v33
    v_sub_f32 v34, v34, v45
    v_sub_f32 v35, v35, v45
    s_lshr_b32 s41, s41, 22
    v_exp_f32 v34, v34
    v_exp_f32 v35, v35
    v_sub_f32 v36, v36, v45
    v_sub_f32 v37, v37, v45
    v_exp_f32 v36, v36
    s_mul_i32 s41, s41, 0x8fb80
    v_exp_f32 v37, v37
    v_sub_f32 v38, v38, v45
    v_sub_f32 v39, v39, v45
    v_exp_f32 v38, v38
    s_mul_i32 s42, s43, 0x540
    v_exp_f32 v39, v39
    v_sub_f32 v40, v40, v45
    v_sub_f32 v41, v41, v45
    v_exp_f32 v40, v40
    s_add_u32 s32, s41, s42
    v_exp_f32 v41, v41
    v_sub_f32 v42, v42, v45
    v_sub_f32 v43, v43, v45
    v_exp_f32 v42, v42
    s_cmp_lt_u32 s43, 5329
    v_exp_f32 v43, v43
    v_sub_f32 v44, v44, v45
    v_exp_f32 v44, v44
    v_add_f32 v116, v32, v33
    v_add_f32 v117, v34, v35
    s_cselect_b32 s14, 0x2fd00c0, 0
    v_add_f32 v118, v36, v37
    v_add_f32 v119, v38, v39
    v_add_f32 v116, v116, v40
    v_add_f32 v117, v117, v41
    v_add_f32 v118, v118, v42
    v_add_f32 v119, v119, v43
    s_add_u32 s33, s32, 0x17f40
    v_add_f32 v116, v116, v44
    v_add_f32 v118, v118, v119
    v_add_f32 v116, v116, v117
    v_add_f32 v45, v116, v118
    v_mov_b32 v14, v45
    s_add_u32 s34, s32, 0x2fe80
    v_permlane32_swap_b32 v13, v29
    v_add_f32 v13, v13, v29
    v_permlane32_swap_b32 v45, v14
    s_add_u32 s35, s32, 0x47dc0
    v_add_f32 v45, v45, v14
    s_nop 1
    v_permlane16_swap_b32 v13, v45
    v_add_f32 v13, v13, v45
    v_rcp_f32 v13, v13
    s_add_u32 s36, s32, 0x5fd00
    v_mov_b32 v45, v13
    s_nop 1
    v_permlane16_swap_b32 v13, v45
    v_mov_b32 v29, v13
    v_mul_f32 v32, v32, v45
    s_add_u32 s37, s32, 0x77c40
    v_mul_f32 v33, v33, v45
    v_permlane32_swap_b32 v13, v29
    v_mul_f32 v0, v0, v13
    v_mul_f32 v1, v1, v13
    s_add_u32 s38, s32, 0x8fb80
    v_mul_f32 v2, v2, v13
    v_mul_f32 v3, v3, v13
    v_mul_f32 v4, v4, v13
    v_mul_f32 v5, v5, v13
    v_mul_f32 v6, v6, v13
    v_mul_f32 v7, v7, v13
    v_mul_f32 v8, v8, v13
    v_mul_f32 v9, v9, v13
    v_mul_f32 v10, v10, v13
    v_mul_f32 v11, v11, v13
    v_mul_f32 v12, v12, v13
    v_cvt_pk_bf16_f32 v0, v0, v1
    v_cvt_pk_bf16_f32 v1, v2, v3
    v_cvt_pk_bf16_f32 v2, v4, v5
    v_cvt_pk_bf16_f32 v3, v6, v7
    v_cvt_pk_bf16_f32 v8, v8, v9
    v_cvt_pk_bf16_f32 v9, v10, v11
    v_cvt_pk_bf16_f32 v10, v12, 0
    v_mov_b32 v11, 0
    v_mul_f32 v16, v16, v29
    v_mul_f32 v17, v17, v29
    v_mul_f32 v18, v18, v29
    v_mul_f32 v19, v19, v29
    v_mul_f32 v20, v20, v29
    v_mul_f32 v21, v21, v29
    v_mul_f32 v22, v22, v29
    v_mul_f32 v23, v23, v29
    v_mul_f32 v24, v24, v29
    v_mul_f32 v25, v25, v29
    v_mul_f32 v26, v26, v29
    v_mul_f32 v27, v27, v29
    v_mul_f32 v28, v28, v29
    v_cvt_pk_bf16_f32 v16, v16, v17
    v_cvt_pk_bf16_f32 v17, v18, v19
    v_cvt_pk_bf16_f32 v18, v20, v21
    v_cvt_pk_bf16_f32 v19, v22, v23
    v_cvt_pk_bf16_f32 v24, v24, v25
    v_cvt_pk_bf16_f32 v25, v26, v27
    v_cvt_pk_bf16_f32 v26, v28, 0
    v_mov_b32 v27, 0
    v_mul_f32 v34, v34, v45
    v_mul_f32 v35, v35, v45
    v_mul_f32 v36, v36, v45
    v_mul_f32 v37, v37, v45
    v_mul_f32 v38, v38, v45
    v_mul_f32 v39, v39, v45
    v_mul_f32 v40, v40, v45
    v_mul_f32 v41, v41, v45
    v_mul_f32 v42, v42, v45
    v_mul_f32 v43, v43, v45
    v_mul_f32 v44, v44, v45
    v_cvt_pk_bf16_f32 v32, v32, v33
    v_cvt_pk_bf16_f32 v33, v34, v35
    v_cvt_pk_bf16_f32 v34, v36, v37
    v_cvt_pk_bf16_f32 v35, v38, v39
    v_cvt_pk_bf16_f32 v40, v40, v41
    v_cvt_pk_bf16_f32 v41, v42, v43
    v_cvt_pk_bf16_f32 v42, v44, 0
    v_mov_b32 v43, 0
    v_add_u32 v170, s40, v170
    v_add_u32 v172, s40, v172
    v_add_u32 v173, s40, v173
    v_add_u32 v174, s40, v174
    v_add_u32 v171, 0xaf0, v171
    v_add_u32 v182, s58, v182
    s_waitcnt lgkmcnt(0)
L_smj:
    s_sub_u32 s40, 0, s40
    s_sub_u32 s58, 0, s58
    s_setprio 1
    s_add_u32 s41, s28, s46
    s_cmp_eq_u32 s41, 3
    s_cbranch_scc1 L_last
    s_barrier
    s_cmp_eq_u32 s28, 2
    s_cbranch_scc1 L_last
    s_add_u32 s28, s28, 1
    v_mfma_f32_16x16x32_bf16 v[108:111], v[60:63], v[0:3], 0
    ds_read_b128 v[144:147], v175 offset:0
    v_mfma_f32_16x16x32_bf16 v[108:111], v[64:67], v[8:11], v[108:111]
    v_mfma_f32_16x16x32_bf16 v[4:7], v[68:71], v[0:3], 0
    v_mfma_f32_16x16x32_bf16 v[4:7], v[72:75], v[8:11], v[4:7]
    v_mfma_f32_16x16x32_bf16 v[112:115], v[76:79], v[0:3], 0
    v_mfma_f32_16x16x32_bf16 v[112:115], v[80:83], v[8:11], v[112:115]
    v_mfma_f32_16x16x32_bf16 v[12:15], v[84:87], v[0:3], 0
    v_mfma_f32_16x16x32_bf16 v[12:15], v[88:91], v[8:11], v[12:15]
    v_mfma_f32_16x16x32_bf16 v[116:119], v[92:95], v[0:3], 0
    v_mfma_f32_16x16x32_bf16 v[116:119], v[96:99], v[8:11], v[116:119]
    v_cvt_pk_bf16_f32 v108, v108, v109
    v_cvt_pk_bf16_f32 v109, v110, v111
    v_mfma_f32_16x16x32_bf16 v[48:51], v[100:103], v[0:3], 0
    v_cvt_pk_bf16_f32 v110, v4, v5
    v_cvt_pk_bf16_f32 v111, v6, v7
    v_mfma_f32_16x16x32_bf16 v[48:51], v[104:107], v[8:11], v[48:51]
    v_cvt_pk_bf16_f32 v112, v112, v113
    v_cvt_pk_bf16_f32 v113, v114, v115
    v_mfma_f32_16x16x32_bf16 v[120:123], v[60:63], v[16:19], 0
    v_cvt_pk_bf16_f32 v114, v12, v13
    v_cvt_pk_bf16_f32 v115, v14, v15
    v_mfma_f32_16x16x32_bf16 v[120:123], v[64:67], v[24:27], v[120:123]
    v_cvt_pk_bf16_f32 v116, v116, v117
    v_cvt_pk_bf16_f32 v117, v118, v119
    v_mfma_f32_16x16x32_bf16 v[20:23], v[68:71], v[16:19], 0
    v_cvt_pk_bf16_f32 v118, v48, v49
    v_cvt_pk_bf16_f32 v119, v50, v51
    v_mfma_f32_16x16x32_bf16 v[20:23], v[72:75], v[24:27], v[20:23]
    ds_read_b128 v[4:7], v175 offset:1024
    v_mfma_f32_16x16x32_bf16 v[124:127], v[76:79], v[16:19], 0
    v_cvt_pk_bf16_f32 v120, v120, v121
    v_cvt_pk_bf16_f32 v121, v122, v123
    v_mfma_f32_16x16x32_bf16 v[124:127], v[80:83], v[24:27], v[124:127]
    ds_read_b128 v[12:15], v175 offset:2048
    v_mfma_f32_16x16x32_bf16 v[28:31], v[84:87], v[16:19], 0
    ds_read_b128 v[0:3], v175 offset:3120
    v_mfma_f32_16x16x32_bf16 v[28:31], v[88:91], v[24:27], v[28:31]
    v_cvt_pk_bf16_f32 v122, v20, v21
    v_cvt_pk_bf16_f32 v123, v22, v23
    v_mfma_f32_16x16x32_bf16 v[128:131], v[92:95], v[16:19], 0
    ds_read_b128 v[8:11], v175 offset:4144
    v_mfma_f32_16x16x32_bf16 v[128:131], v[96:99], v[24:27], v[128:131]
    v_cvt_pk_bf16_f32 v124, v124, v125
    v_cvt_pk_bf16_f32 v125, v126, v127
    v_mfma_f32_16x16x32_bf16 v[52:55], v[100:103], v[16:19], 0
    v_cvt_pk_bf16_f32 v126, v28, v29
    v_cvt_pk_bf16_f32 v127, v30, v31
    v_mfma_f32_16x16x32_bf16 v[52:55], v[104:107], v[24:27], v[52:55]
    ds_read_b128 v[20:23], v175 offset:5168
    v_mfma_f32_16x16x32_bf16 v[132:135], v[60:63], v[32:35], 0
    v_cvt_pk_bf16_f32 v128, v128, v129
    v_cvt_pk_bf16_f32 v129, v130, v131
    v_mfma_f32_16x16x32_bf16 v[132:135], v[64:67], v[40:43], v[132:135]
    v_mfma_f32_16x16x32_bf16 v[36:39], v[68:71], v[32:35], 0
    v_mfma_f32_16x16x32_bf16 v[36:39], v[72:75], v[40:43], v[36:39]
    v_mfma_f32_16x16x32_bf16 v[136:139], v[76:79], v[32:35], 0
    v_cvt_pk_bf16_f32 v130, v52, v53
    v_cvt_pk_bf16_f32 v131, v54, v55
    v_mfma_f32_16x16x32_bf16 v[136:139], v[80:83], v[40:43], v[136:139]
    v_mfma_f32_16x16x32_bf16 v[44:47], v[84:87], v[32:35], 0
    v_mfma_f32_16x16x32_bf16 v[44:47], v[88:91], v[40:43], v[44:47]
    v_cvt_pk_bf16_f32 v132, v132, v133
    v_cvt_pk_bf16_f32 v133, v134, v135
    v_mfma_f32_16x16x32_bf16 v[140:143], v[92:95], v[32:35], 0
    v_cvt_pk_bf16_f32 v134, v36, v37
    v_cvt_pk_bf16_f32 v135, v38, v39
    v_mfma_f32_16x16x32_bf16 v[140:143], v[96:99], v[40:43], v[140:143]
    v_cvt_pk_bf16_f32 v136, v136, v137
    v_cvt_pk_bf16_f32 v137, v138, v139
    v_mfma_f32_16x16x32_bf16 v[56:59], v[100:103], v[32:35], 0
    v_cvt_pk_bf16_f32 v138, v44, v45
    v_cvt_pk_bf16_f32 v139, v46, v47
    v_mfma_f32_16x16x32_bf16 v[56:59], v[104:107], v[40:43], v[56:59]
    s_waitcnt lgkmcnt(5)
    v_mfma_f32_16x16x32_bf16 v[60:63], v[108:111], v[144:147], 0
    s_waitcnt lgkmcnt(4)
    v_mfma_f32_16x16x32_bf16 v[60:63], v[112:115], v[4:7], v[60:63]
    v_cvt_pk_bf16_f32 v140, v140, v141
    v_cvt_pk_bf16_f32 v141, v142, v143
    s_waitcnt lgkmcnt(3)
    v_mfma_f32_16x16x32_bf16 v[60:63], v[116:119], v[12:15], v[60:63]
    v_mfma_f32_16x16x32_bf16 v[68:71], v[120:123], v[144:147], 0
    v_mfma_f32_16x16x32_bf16 v[68:71], v[124:127], v[4:7], v[68:71]
    v_mfma_f32_16x16x32_bf16 v[68:71], v[128:131], v[12:15], v[68:71]
    v_cvt_pk_bf16_f32 v142, v56, v57
    v_cvt_pk_bf16_f32 v143, v58, v59
    v_mfma_f32_16x16x32_bf16 v[76:79], v[132:135], v[144:147], 0
    ds_read_b128 v[144:147], v175 offset:6240
    v_mfma_f32_16x16x32_bf16 v[76:79], v[136:139], v[4:7], v[76:79]
    ds_read_b128 v[4:7], v175 offset:7264
    v_mfma_f32_16x16x32_bf16 v[76:79], v[140:143], v[12:15], v[76:79]
    ds_read_b128 v[12:15], v175 offset:8288
    s_waitcnt lgkmcnt(5)
    v_mfma_f32_16x16x32_bf16 v[64:67], v[108:111], v[0:3], 0
    s_waitcnt lgkmcnt(4)
    v_mfma_f32_16x16x32_bf16 v[64:67], v[112:115], v[8:11], v[64:67]
    s_waitcnt lgkmcnt(3)
    v_mfma_f32_16x16x32_bf16 v[64:67], v[116:119], v[20:23], v[64:67]
    v_mfma_f32_16x16x32_bf16 v[72:75], v[120:123], v[0:3], 0
    v_mfma_f32_16x16x32_bf16 v[72:75], v[124:127], v[8:11], v[72:75]
    v_mfma_f32_16x16x32_bf16 v[72:75], v[128:131], v[20:23], v[72:75]
    v_mfma_f32_16x16x32_bf16 v[80:83], v[132:135], v[0:3], 0
    ds_read_b128 v[0:3], v175 offset:9360
    v_mfma_f32_16x16x32_bf16 v[80:83], v[136:139], v[8:11], v[80:83]
    ds_read_b128 v[8:11], v175 offset:10384
    v_mfma_f32_16x16x32_bf16 v[80:83], v[140:143], v[20:23], v[80:83]
    ds_read_b128 v[20:23], v175 offset:11408
    s_waitcnt lgkmcnt(5)
    v_mfma_f32_16x16x32_bf16 v[84:87], v[108:111], v[144:147], 0
    v_cvt_pk_bf16_f32 v44, v60, v64
    v_cvt_pk_bf16_f32 v32, v61, v65
    s_waitcnt lgkmcnt(4)
    v_mfma_f32_16x16x32_bf16 v[84:87], v[112:115], v[4:7], v[84:87]
    v_cvt_pk_bf16_f32 v36, v62, v66
    v_cvt_pk_bf16_f32 v40, v63, v67
    s_waitcnt lgkmcnt(3)
    v_mfma_f32_16x16x32_bf16 v[84:87], v[116:119], v[12:15], v[84:87]
    v_cvt_pk_bf16_f32 v48, v68, v72
    v_cvt_pk_bf16_f32 v52, v69, v73
    v_mfma_f32_16x16x32_bf16 v[92:95], v[120:123], v[144:147], 0
    v_cvt_pk_bf16_f32 v56, v70, v74
    v_cvt_pk_bf16_f32 v160, v71, v75
    v_mfma_f32_16x16x32_bf16 v[92:95], v[124:127], v[4:7], v[92:95]
    v_cvt_pk_bf16_f32 v164, v76, v80
    v_cvt_pk_bf16_f32 v148, v77, v81
    v_mfma_f32_16x16x32_bf16 v[92:95], v[128:131], v[12:15], v[92:95]
    v_cvt_pk_bf16_f32 v152, v78, v82
    v_cvt_pk_bf16_f32 v156, v79, v83
    v_mfma_f32_16x16x32_bf16 v[100:103], v[132:135], v[144:147], 0
    ds_read_b128 v[144:147], v175 offset:12480
    v_mfma_f32_16x16x32_bf16 v[100:103], v[136:139], v[4:7], v[100:103]
    ds_read_b128 v[4:7], v175 offset:13504
    v_mfma_f32_16x16x32_bf16 v[100:103], v[140:143], v[12:15], v[100:103]
    ds_read_b128 v[12:15], v175 offset:14528
    s_waitcnt lgkmcnt(5)
    v_mfma_f32_16x16x32_bf16 v[88:91], v[108:111], v[0:3], 0
    s_waitcnt lgkmcnt(4)
    v_mfma_f32_16x16x32_bf16 v[88:91], v[112:115], v[8:11], v[88:91]
    s_waitcnt lgkmcnt(3)
    v_mfma_f32_16x16x32_bf16 v[88:91], v[116:119], v[20:23], v[88:91]
    v_mfma_f32_16x16x32_bf16 v[96:99], v[120:123], v[0:3], 0
    v_mfma_f32_16x16x32_bf16 v[96:99], v[124:127], v[8:11], v[96:99]
    v_mfma_f32_16x16x32_bf16 v[96:99], v[128:131], v[20:23], v[96:99]
    v_mfma_f32_16x16x32_bf16 v[104:107], v[132:135], v[0:3], 0
    ds_read_b128 v[0:3], v175 offset:15600
    v_mfma_f32_16x16x32_bf16 v[104:107], v[136:139], v[8:11], v[104:107]
    ds_read_b128 v[8:11], v175 offset:16624
    v_mfma_f32_16x16x32_bf16 v[104:107], v[140:143], v[20:23], v[104:107]
    ds_read_b128 v[20:23], v175 offset:17648
    s_waitcnt lgkmcnt(5)
    v_mfma_f32_16x16x32_bf16 v[60:63], v[108:111], v[144:147], 0
    ds_read_b32 v168, v175 offset:3072
    v_cvt_pk_bf16_f32 v45, v84, v88
    v_cvt_pk_bf16_f32 v33, v85, v89
    s_waitcnt lgkmcnt(5)
    v_mfma_f32_16x16x32_bf16 v[60:63], v[112:115], v[4:7], v[60:63]
    v_cvt_pk_bf16_f32 v37, v86, v90
    v_cvt_pk_bf16_f32 v41, v87, v91
    s_waitcnt lgkmcnt(4)
    v_mfma_f32_16x16x32_bf16 v[60:63], v[116:119], v[12:15], v[60:63]
    v_cvt_pk_bf16_f32 v49, v92, v96
    v_cvt_pk_bf16_f32 v53, v93, v97
    v_mfma_f32_16x16x32_bf16 v[68:71], v[120:123], v[144:147], 0
    v_cvt_pk_bf16_f32 v57, v94, v98
    v_cvt_pk_bf16_f32 v161, v95, v99
    v_mfma_f32_16x16x32_bf16 v[68:71], v[124:127], v[4:7], v[68:71]
    v_cvt_pk_bf16_f32 v165, v100, v104
    v_cvt_pk_bf16_f32 v149, v101, v105
    v_mfma_f32_16x16x32_bf16 v[68:71], v[128:131], v[12:15], v[68:71]
    v_cvt_pk_bf16_f32 v153, v102, v106
    s_waitcnt lgkmcnt(0)
    v_readfirstlane_b32 s41, v168
    v_cvt_pk_bf16_f32 v157, v103, v107
    v_mfma_f32_16x16x32_bf16 v[76:79], v[132:135], v[144:147], 0
    s_cmp_lt_u32 s41, s39
    s_cbranch_scc1 L_spin1
L_spun1:
    ds_read_b128 v[84:87], v170 offset:0
    v_mfma_f32_16x16x32_bf16 v[76:79], v[136:139], v[4:7], v[76:79]
    ds_read_b128 v[88:91], v170 offset:64
    v_mfma_f32_16x16x32_bf16 v[76:79], v[140:143], v[12:15], v[76:79]
    ds_read_b128 v[92:95], v170 offset:128
    v_mfma_f32_16x16x32_bf16 v[64:67], v[108:111], v[0:3], 0
    ds_read_b128 v[96:99], v170 offset:3072
    v_mfma_f32_16x16x32_bf16 v[64:67], v[112:115], v[8:11], v[64:67]
    ds_read_b128 v[100:103], v170 offset:3136
    v_mfma_f32_16x16x32_bf16 v[64:67], v[116:119], v[20:23], v[64:67]
    ds_read_b128 v[104:107], v170 offset:3200
    v_mfma_f32_16x16x32_bf16 v[72:75], v[120:123], v[0:3], 0
    ds_read_b128 v[120:123], v170 offset:6144
    v_mfma_f32_16x16x32_bf16 v[72:75], v[124:127], v[8:11], v[72:75]
    ds_read_b128 v[124:127], v170 offset:6208
    v_mfma_f32_16x16x32_bf16 v[72:75], v[128:131], v[20:23], v[72:75]
    ds_read_b128 v[128:131], v170 offset:6272
    v_mfma_f32_16x16x32_bf16 v[80:83], v[132:135], v[0:3], 0
    v_cvt_pk_bf16_f32 v46, v60, v64
    v_cvt_pk_bf16_f32 v34, v61, v65
    v_mfma_f32_16x16x32_bf16 v[80:83], v[136:139], v[8:11], v[80:83]
    v_cvt_pk_bf16_f32 v38, v62, v66
    v_cvt_pk_bf16_f32 v42, v63, v67
    v_mfma_f32_16x16x32_bf16 v[80:83], v[140:143], v[20:23], v[80:83]
    v_cvt_pk_bf16_f32 v50, v68, v72
    v_cvt_pk_bf16_f32 v54, v69, v73
    s_waitcnt lgkmcnt(8)
    v_mfma_f32_16x16x32_bf16 v[108:111], v[184:187], v[84:87], 0
    v_cvt_pk_bf16_f32 v58, v70, v74
    v_cvt_pk_bf16_f32 v162, v71, v75
    s_waitcnt lgkmcnt(7)
    v_mfma_f32_16x16x32_bf16 v[108:111], v[188:191], v[88:91], v[108:111]
    ds_read_b128 v[72:75], v171 offset:0
    s_waitcnt lgkmcnt(7)
    v_mfma_f32_16x16x32_bf16 v[108:111], v[192:195], v[92:95], v[108:111]
    v_cvt_pk_bf16_f32 v166, v76, v80
    v_cvt_pk_bf16_f32 v150, v77, v81
    v_mfma_f32_16x16x32_bf16 v[16:19], v[196:199], v[84:87], 0
    v_cvt_pk_bf16_f32 v154, v78, v82
    v_cvt_pk_bf16_f32 v158, v79, v83
    v_mfma_f32_16x16x32_bf16 v[16:19], v[200:203], v[88:91], v[16:19]
    ds_read_b128 v[76:79], v171 offset:64
    v_mfma_f32_16x16x32_bf16 v[16:19], v[204:207], v[92:95], v[16:19]
    ds_read_b128 v[80:83], v171 offset:128
    v_mfma_f32_16x16x32_bf16 v[112:115], v[208:211], v[84:87], 0
    buffer_store_dwordx3 v[44:46], v179, s[12:15], s32 offen offset:0 sc1
    v_mfma_f32_16x16x32_bf16 v[112:115], v[212:215], v[88:91], v[112:115]
    v_cvt_pk_bf16_f32 v108, v108, v109
    v_cvt_pk_bf16_f32 v109, v110, v111
    v_mfma_f32_16x16x32_bf16 v[112:115], v[216:219], v[92:95], v[112:115]
    v_mfma_f32_16x16x32_bf16 v[20:23], v[220:223], v[84:87], 0
    v_cvt_pk_bf16_f32 v110, v16, v17
    v_cvt_pk_bf16_f32 v111, v18, v19
    v_mfma_f32_16x16x32_bf16 v[20:23], v[224:227], v[88:91], v[20:23]
    v_mfma_f32_16x16x32_bf16 v[20:23], v[228:231], v[92:95], v[20:23]
    v_mfma_f32_16x16x32_bf16 v[116:119], v[232:235], v[84:87], 0
    v_mfma_f32_16x16x32_bf16 v[116:119], v[236:239], v[88:91], v[116:119]
    v_mfma_f32_16x16x32_bf16 v[116:119], v[240:243], v[92:95], v[116:119]
    v_cvt_pk_bf16_f32 v112, v112, v113
    v_cvt_pk_bf16_f32 v113, v114, v115
    v_mfma_f32_16x16x32_bf16 v[24:27], v[244:247], v[84:87], 0
    v_mfma_f32_16x16x32_bf16 v[24:27], v[248:251], v[88:91], v[24:27]
    v_mfma_f32_16x16x32_bf16 v[24:27], v[252:255], v[92:95], v[24:27]
    v_cvt_pk_bf16_f32 v114, v20, v21
    v_cvt_pk_bf16_f32 v115, v22, v23
    s_waitcnt lgkmcnt(8)
    v_mfma_f32_16x16x32_bf16 v[132:135], v[184:187], v[96:99], 0
    v_cvt_pk_bf16_f32 v116, v116, v117
    v_cvt_pk_bf16_f32 v117, v118, v119
    s_waitcnt lgkmcnt(7)
    v_mfma_f32_16x16x32_bf16 v[132:135], v[188:191], v[100:103], v[132:135]
    buffer_store_dwordx3 v[32:34], v178, s[12:15], s32 offen offset:768 sc1
    s_waitcnt lgkmcnt(6)
    v_mfma_f32_16x16x32_bf16 v[132:135], v[192:195], v[104:107], v[132:135]
    v_cvt_pk_bf16_f32 v118, v24, v25
    v_cvt_pk_bf16_f32 v119, v26, v27
    v_mfma_f32_16x16x32_bf16 v[60:63], v[196:199], v[96:99], 0
    v_mfma_f32_16x16x32_bf16 v[60:63], v[200:203], v[100:103], v[60:63]
    v_mfma_f32_16x16x32_bf16 v[60:63], v[204:207], v[104:107], v[60:63]
    v_mfma_f32_16x16x32_bf16 v[136:139], v[208:211], v[96:99], 0
    v_mfma_f32_16x16x32_bf16 v[136:139], v[212:215], v[100:103], v[136:139]
    v_mfma_f32_16x16x32_bf16 v[136:139], v[216:219], v[104:107], v[136:139]
    v_cvt_pk_bf16_f32 v132, v132, v133
    v_cvt_pk_bf16_f32 v133, v134, v135
    v_mfma_f32_16x16x32_bf16 v[64:67], v[220:223], v[96:99], 0
    v_mfma_f32_16x16x32_bf16 v[64:67], v[224:227], v[100:103], v[64:67]
    v_mfma_f32_16x16x32_bf16 v[64:67], v[228:231], v[104:107], v[64:67]
    v_cvt_pk_bf16_f32 v134, v60, v61
    v_cvt_pk_bf16_f32 v135, v62, v63
    v_mfma_f32_16x16x32_bf16 v[140:143], v[232:235], v[96:99], 0
    v_cvt_pk_bf16_f32 v136, v136, v137
    v_cvt_pk_bf16_f32 v137, v138, v139
    v_mfma_f32_16x16x32_bf16 v[140:143], v[236:239], v[100:103], v[140:143]
    ds_read_b64_tr_b16 v[60:61], v172 offset:0
    v_mfma_f32_16x16x32_bf16 v[140:143], v[240:243], v[104:107], v[140:143]
    buffer_store_dwordx3 v[36:38], v179, s[12:15], s33 offen offset:192 sc1
    v_mfma_f32_16x16x32_bf16 v[68:71], v[244:247], v[96:99], 0
    v_cvt_pk_bf16_f32 v138, v64, v65
    v_cvt_pk_bf16_f32 v139, v66, v67
    v_mfma_f32_16x16x32_bf16 v[68:71], v[248:251], v[100:103], v[68:71]
    ds_read_b64_tr_b16 v[62:63], v172 offset:3072
    v_mfma_f32_16x16x32_bf16 v[68:71], v[252:255], v[104:107], v[68:71]
    ds_read_b64_tr_b16 v[64:65], v172 offset:6144
    v_mfma_f32_16x16x32_bf16 v[0:3], v[84:87], v[108:111], 0
    v_cvt_pk_bf16_f32 v140, v140, v141
    v_cvt_pk_bf16_f32 v141, v142, v143
    v_mfma_f32_16x16x32_bf16 v[0:3], v[88:91], v[112:115], v[0:3]
    ds_read_b64_tr_b16 v[66:67], v174 offset:0
    v_mfma_f32_16x16x32_bf16 v[0:3], v[92:95], v[116:119], v[0:3]
    v_mfma_f32_16x16x32_bf16 v[4:7], v[96:99], v[108:111], 0
    v_cvt_pk_bf16_f32 v142, v68, v69
    v_cvt_pk_bf16_f32 v143, v70, v71
    v_mfma_f32_16x16x32_bf16 v[4:7], v[100:103], v[112:115], v[4:7]
    ds_read_b64_tr_b16 v[68:69], v173 offset:0
    v_mfma_f32_16x16x32_bf16 v[4:7], v[104:107], v[116:119], v[4:7]
    ds_read_b64_tr_b16 v[70:71], v173 offset:3072
    s_waitcnt lgkmcnt(11)
    v_mfma_f32_16x16x32_bf16 v[8:11], v[120:123], v[108:111], 0
    s_waitcnt lgkmcnt(10)
    v_mfma_f32_16x16x32_bf16 v[8:11], v[124:127], v[112:115], v[8:11]
    s_waitcnt lgkmcnt(9)
    v_mfma_f32_16x16x32_bf16 v[8:11], v[128:131], v[116:119], v[8:11]
    s_waitcnt lgkmcnt(8)
    v_mfma_f32_16x16x32_bf16 v[12:15], v[72:75], v[84:87], v[180:183]
    buffer_store_dwordx3 v[40:42], v177, s[12:15], s33 offen offset:960 sc1
    s_waitcnt lgkmcnt(7)
    v_mfma_f32_16x16x32_bf16 v[12:15], v[76:79], v[88:91], v[12:15]
    s_waitcnt lgkmcnt(6)
    v_mfma_f32_16x16x32_bf16 v[12:15], v[80:83], v[92:95], v[12:15]
    v_mfma_f32_16x16x32_bf16 v[108:111], v[184:187], v[120:123], 0
    v_mfma_f32_16x16x32_bf16 v[108:111], v[188:191], v[124:127], v[108:111]
    v_mfma_f32_16x16x32_bf16 v[108:111], v[192:195], v[128:131], v[108:111]
    v_mfma_f32_16x16x32_bf16 v[16:19], v[196:199], v[120:123], 0
    v_mfma_f32_16x16x32_bf16 v[16:19], v[200:203], v[124:127], v[16:19]
    v_mfma_f32_16x16x32_bf16 v[16:19], v[204:207], v[128:131], v[16:19]
    v_mfma_f32_16x16x32_bf16 v[112:115], v[208:211], v[120:123], 0
    v_mfma_f32_16x16x32_bf16 v[112:115], v[212:215], v[124:127], v[112:115]
    v_mfma_f32_16x16x32_bf16 v[112:115], v[216:219], v[128:131], v[112:115]
    v_mfma_f32_16x16x32_bf16 v[20:23], v[220:223], v[120:123], 0
    v_mfma_f32_16x16x32_bf16 v[20:23], v[224:227], v[124:127], v[20:23]
    v_cvt_pk_bf16_f32 v108, v108, v109
    v_cvt_pk_bf16_f32 v109, v110, v111
    v_mfma_f32_16x16x32_bf16 v[20:23], v[228:231], v[128:131], v[20:23]
    v_cvt_pk_bf16_f32 v110, v16, v17
    v_cvt_pk_bf16_f32 v111, v18, v19
    v_mfma_f32_16x16x32_bf16 v[116:119], v[232:235], v[120:123], 0
    v_cvt_pk_bf16_f32 v112, v112, v113
    v_cvt_pk_bf16_f32 v113, v114, v115
    v_mfma_f32_16x16x32_bf16 v[116:119], v[236:239], v[124:127], v[116:119]
    v_mfma_f32_16x16x32_bf16 v[116:119], v[240:243], v[128:131], v[116:119]
    v_mfma_f32_16x16x32_bf16 v[24:27], v[244:247], v[120:123], 0
    v_cvt_pk_bf16_f32 v114, v20, v21
    v_cvt_pk_bf16_f32 v115, v22, v23
    v_mfma_f32_16x16x32_bf16 v[24:27], v[248:251], v[124:127], v[24:27]
    v_mfma_f32_16x16x32_bf16 v[24:27], v[252:255], v[128:131], v[24:27]
    v_mfma_f32_16x16x32_bf16 v[28:31], v[72:75], v[96:99], v[180:183]
    v_mfma_f32_16x16x32_bf16 v[28:31], v[76:79], v[100:103], v[28:31]
    v_mfma_f32_16x16x32_bf16 v[28:31], v[80:83], v[104:107], v[28:31]
    v_cvt_pk_bf16_f32 v116, v116, v117
    v_cvt_pk_bf16_f32 v117, v118, v119
    v_mfma_f32_16x16x32_bf16 v[44:47], v[72:75], v[120:123], v[180:183]
    ds_read_b64_tr_b16 v[72:73], v173 offset:6144
    v_mfma_f32_16x16x32_bf16 v[44:47], v[76:79], v[124:127], v[44:47]
    v_cvt_pk_bf16_f32 v118, v24, v25
    v_cvt_pk_bf16_f32 v119, v26, v27
    v_mfma_f32_16x16x32_bf16 v[44:47], v[80:83], v[128:131], v[44:47]
    ds_read_b64_tr_b16 v[74:75], v174 offset:32
    v_mfma_f32_16x16x32_bf16 v[16:19], v[84:87], v[132:135], 0
    ds_read_b64_tr_b16 v[76:77], v172 offset:64
    v_mfma_f32_16x16x32_bf16 v[16:19], v[88:91], v[136:139], v[16:19]
    ds_read_b64_tr_b16 v[78:79], v172 offset:3136
    v_mfma_f32_16x16x32_bf16 v[16:19], v[92:95], v[140:143], v[16:19]
    ds_read_b64_tr_b16 v[80:81], v172 offset:6208
    v_mfma_f32_16x16x32_bf16 v[20:23], v[96:99], v[132:135], 0
    ds_read_b64_tr_b16 v[82:83], v174 offset:64
    v_mfma_f32_16x16x32_bf16 v[20:23], v[100:103], v[136:139], v[20:23]
    v_mfma_f32_16x16x32_bf16 v[20:23], v[104:107], v[140:143], v[20:23]
    v_mfma_f32_16x16x32_bf16 v[24:27], v[120:123], v[132:135], 0
    v_mfma_f32_16x16x32_bf16 v[24:27], v[124:127], v[136:139], v[24:27]
    v_mfma_f32_16x16x32_bf16 v[24:27], v[128:131], v[140:143], v[24:27]
    v_mfma_f32_16x16x32_bf16 v[32:35], v[84:87], v[108:111], 0
    v_mfma_f32_16x16x32_bf16 v[32:35], v[88:91], v[112:115], v[32:35]
    v_mfma_f32_16x16x32_bf16 v[32:35], v[92:95], v[116:119], v[32:35]
    v_mfma_f32_16x16x32_bf16 v[36:39], v[96:99], v[108:111], 0
    v_mfma_f32_16x16x32_bf16 v[36:39], v[100:103], v[112:115], v[36:39]
    s_mov_b64 exec, 0xffff
    ds_write_b32 v182, v13 offset:0
    v_mfma_f32_16x16x32_bf16 v[36:39], v[104:107], v[116:119], v[36:39]
    ds_write_b32 v182, v29 offset:64
    v_mfma_f32_16x16x32_bf16 v[40:43], v[120:123], v[108:111], 0
    ds_write_b32 v182, v45 offset:128
    v_mfma_f32_16x16x32_bf16 v[40:43], v[124:127], v[112:115], v[40:43]
    s_mov_b64 exec, -1
    v_mfma_f32_16x16x32_bf16 v[40:43], v[128:131], v[116:119], v[40:43]
    ds_read_b64_tr_b16 v[84:85], v173 offset:64
    ds_read_b64_tr_b16 v[86:87], v173 offset:3136
    ds_read_b64_tr_b16 v[88:89], v173 offset:6208
    ds_read_b64_tr_b16 v[90:91], v174 offset:96
    ds_read_b64_tr_b16 v[92:93], v172 offset:128
    ds_read_b64_tr_b16 v[94:95], v172 offset:3200
    ds_read_b64_tr_b16 v[96:97], v172 offset:6272
    ds_read_b64_tr_b16 v[98:99], v174 offset:128
    ds_read_b64_tr_b16 v[100:101], v173 offset:128
    ds_read_b64_tr_b16 v[102:103], v173 offset:3200
    ds_read_b64_tr_b16 v[104:105], v173 offset:6272
    ds_read_b64_tr_b16 v[106:107], v174 offset:160
    s_waitcnt lgkmcnt(12)
    s_branch L_loop
L_spin1:
    ds_read_b32 v168, v175 offset:3072
    s_waitcnt lgkmcnt(0)
    v_readfirstlane_b32 s41, v168
    s_nop 0
    s_cmp_lt_u32 s41, s39
    s_cbranch_scc1 L_spin1
    s_branch L_spun1
L_last:
    v_mfma_f32_16x16x32_bf16 v[108:111], v[60:63], v[0:3], 0
    ds_read_b128 v[184:187], v175 offset:0
    v_mfma_f32_16x16x32_bf16 v[108:111], v[64:67], v[8:11], v[108:111]
    ds_read_b128 v[188:191], v175 offset:1024
    v_mfma_f32_16x16x32_bf16 v[4:7], v[68:71], v[0:3], 0
    ds_read_b128 v[192:195], v175 offset:2048
    v_mfma_f32_16x16x32_bf16 v[4:7], v[72:75], v[8:11], v[4:7]
    ds_read_b128 v[196:199], v175 offset:3120
    v_mfma_f32_16x16x32_bf16 v[112:115], v[76:79], v[0:3], 0
    ds_read_b128 v[200:203], v175 offset:4144
    v_mfma_f32_16x16x32_bf16 v[112:115], v[80:83], v[8:11], v[112:115]
    ds_read_b128 v[204:207], v175 offset:5168
    v_mfma_f32_16x16x32_bf16 v[12:15], v[84:87], v[0:3], 0
    ds_read_b128 v[208:211], v175 offset:6240
    v_mfma_f32_16x16x32_bf16 v[12:15], v[88:91], v[8:11], v[12:15]
    ds_read_b128 v[212:215], v175 offset:7264
    v_mfma_f32_16x16x32_bf16 v[116:119], v[92:95], v[0:3], 0
    ds_read_b128 v[216:219], v175 offset:8288
    v_mfma_f32_16x16x32_bf16 v[116:119], v[96:99], v[8:11], v[116:119]
    ds_read_b128 v[220:223], v175 offset:9360
    v_mfma_f32_16x16x32_bf16 v[48:51], v[100:103], v[0:3], 0
    ds_read_b128 v[224:227], v175 offset:10384
    v_mfma_f32_16x16x32_bf16 v[48:51], v[104:107], v[8:11], v[48:51]
    ds_read_b128 v[228:231], v175 offset:11408
    v_mfma_f32_16x16x32_bf16 v[120:123], v[60:63], v[16:19], 0
    ds_read_b128 v[232:235], v175 offset:12480
    v_mfma_f32_16x16x32_bf16 v[120:123], v[64:67], v[24:27], v[120:123]
    ds_read_b128 v[236:239], v175 offset:13504
    v_mfma_f32_16x16x32_bf16 v[20:23], v[68:71], v[16:19], 0
    ds_read_b128 v[240:243], v175 offset:14528
    v_mfma_f32_16x16x32_bf16 v[20:23], v[72:75], v[24:27], v[20:23]
    ds_read_b128 v[244:247], v175 offset:15600
    v_mfma_f32_16x16x32_bf16 v[124:127], v[76:79], v[16:19], 0
    ds_read_b128 v[248:251], v175 offset:16624
    v_mfma_f32_16x16x32_bf16 v[124:127], v[80:83], v[24:27], v[124:127]
    ds_read_b128 v[252:255], v175 offset:17648
    v_mfma_f32_16x16x32_bf16 v[28:31], v[84:87], v[16:19], 0
    v_cvt_pk_bf16_f32 v108, v108, v109
    v_cvt_pk_bf16_f32 v109, v110, v111
    v_mfma_f32_16x16x32_bf16 v[28:31], v[88:91], v[24:27], v[28:31]
    v_cvt_pk_bf16_f32 v110, v4, v5
    v_cvt_pk_bf16_f32 v111, v6, v7
    v_mfma_f32_16x16x32_bf16 v[128:131], v[92:95], v[16:19], 0
    v_cvt_pk_bf16_f32 v112, v112, v113
    v_cvt_pk_bf16_f32 v113, v114, v115
    v_mfma_f32_16x16x32_bf16 v[128:131], v[96:99], v[24:27], v[128:131]
    v_cvt_pk_bf16_f32 v114, v12, v13
    v_cvt_pk_bf16_f32 v115, v14, v15
    v_mfma_f32_16x16x32_bf16 v[52:55], v[100:103], v[16:19], 0
    v_cvt_pk_bf16_f32 v116, v116, v117
    v_cvt_pk_bf16_f32 v117, v118, v119
    v_mfma_f32_16x16x32_bf16 v[52:55], v[104:107], v[24:27], v[52:55]
    v_cvt_pk_bf16_f32 v118, v48, v49
    v_cvt_pk_bf16_f32 v119, v50, v51
    v_mfma_f32_16x16x32_bf16 v[132:135], v[60:63], v[32:35], 0
    v_cvt_pk_bf16_f32 v120, v120, v121
    v_cvt_pk_bf16_f32 v121, v122, v123
    v_mfma_f32_16x16x32_bf16 v[132:135], v[64:67], v[40:43], v[132:135]
    v_cvt_pk_bf16_f32 v122, v20, v21
    v_cvt_pk_bf16_f32 v123, v22, v23
    v_mfma_f32_16x16x32_bf16 v[36:39], v[68:71], v[32:35], 0
    v_cvt_pk_bf16_f32 v124, v124, v125
    v_cvt_pk_bf16_f32 v125, v126, v127
    v_mfma_f32_16x16x32_bf16 v[36:39], v[72:75], v[40:43], v[36:39]
    v_cvt_pk_bf16_f32 v126, v28, v29
    v_cvt_pk_bf16_f32 v127, v30, v31
    v_mfma_f32_16x16x32_bf16 v[136:139], v[76:79], v[32:35], 0
    v_cvt_pk_bf16_f32 v128, v128, v129
    v_cvt_pk_bf16_f32 v129, v130, v131
    v_mfma_f32_16x16x32_bf16 v[136:139], v[80:83], v[40:43], v[136:139]
    v_cvt_pk_bf16_f32 v130, v52, v53
    v_cvt_pk_bf16_f32 v131, v54, v55
    v_mfma_f32_16x16x32_bf16 v[44:47], v[84:87], v[32:35], 0
    v_cvt_pk_bf16_f32 v132, v132, v133
    v_cvt_pk_bf16_f32 v133, v134, v135
    v_mfma_f32_16x16x32_bf16 v[44:47], v[88:91], v[40:43], v[44:47]
    v_cvt_pk_bf16_f32 v134, v36, v37
    v_cvt_pk_bf16_f32 v135, v38, v39
    v_mfma_f32_16x16x32_bf16 v[140:143], v[92:95], v[32:35], 0
    v_cvt_pk_bf16_f32 v136, v136, v137
    v_cvt_pk_bf16_f32 v137, v138, v139
    v_mfma_f32_16x16x32_bf16 v[140:143], v[96:99], v[40:43], v[140:143]
    v_mfma_f32_16x16x32_bf16 v[56:59], v[100:103], v[32:35], 0
    v_mfma_f32_16x16x32_bf16 v[56:59], v[104:107], v[40:43], v[56:59]
    v_cvt_pk_bf16_f32 v138, v44, v45
    v_cvt_pk_bf16_f32 v139, v46, v47
    s_waitcnt lgkmcnt(15)
    v_mfma_f32_16x16x32_bf16 v[144:147], v[108:111], v[184:187], 0
    v_mfma_f32_16x16x32_bf16 v[144:147], v[112:115], v[188:191], v[144:147]
    v_mfma_f32_16x16x32_bf16 v[144:147], v[116:119], v[192:195], v[144:147]
    s_waitcnt lgkmcnt(14)
    v_mfma_f32_16x16x32_bf16 v[148:151], v[108:111], v[196:199], 0
    v_cvt_pk_bf16_f32 v140, v140, v141
    v_cvt_pk_bf16_f32 v141, v142, v143
    s_waitcnt lgkmcnt(13)
    v_mfma_f32_16x16x32_bf16 v[148:151], v[112:115], v[200:203], v[148:151]
    v_cvt_pk_bf16_f32 v142, v56, v57
    v_cvt_pk_bf16_f32 v143, v58, v59
    s_waitcnt lgkmcnt(12)
    v_mfma_f32_16x16x32_bf16 v[148:151], v[116:119], v[204:207], v[148:151]
    s_waitcnt lgkmcnt(11)
    v_mfma_f32_16x16x32_bf16 v[152:155], v[108:111], v[208:211], 0
    s_waitcnt lgkmcnt(10)
    v_mfma_f32_16x16x32_bf16 v[152:155], v[112:115], v[212:215], v[152:155]
    s_waitcnt lgkmcnt(9)
    v_mfma_f32_16x16x32_bf16 v[152:155], v[116:119], v[216:219], v[152:155]
    s_waitcnt lgkmcnt(8)
    v_mfma_f32_16x16x32_bf16 v[156:159], v[108:111], v[220:223], 0
    s_waitcnt lgkmcnt(7)
    v_mfma_f32_16x16x32_bf16 v[156:159], v[112:115], v[224:227], v[156:159]
    s_waitcnt lgkmcnt(6)
    v_mfma_f32_16x16x32_bf16 v[156:159], v[116:119], v[228:231], v[156:159]
    s_waitcnt lgkmcnt(5)
    v_mfma_f32_16x16x32_bf16 v[48:51], v[108:111], v[232:235], 0
    s_waitcnt lgkmcnt(4)
    v_mfma_f32_16x16x32_bf16 v[48:51], v[112:115], v[236:239], v[48:51]
    v_cvt_pk_bf16_f32 v0, v144, v148
    v_cvt_pk_bf16_f32 v4, v145, v149
    s_waitcnt lgkmcnt(3)
    v_mfma_f32_16x16x32_bf16 v[48:51], v[116:119], v[240:243], v[48:51]
    v_cvt_pk_bf16_f32 v8, v146, v150
    v_cvt_pk_bf16_f32 v12, v147, v151
    s_waitcnt lgkmcnt(2)
    v_mfma_f32_16x16x32_bf16 v[52:55], v[108:111], v[244:247], 0
    v_cvt_pk_bf16_f32 v1, v152, v156
    v_cvt_pk_bf16_f32 v5, v153, v157
    s_waitcnt lgkmcnt(1)
    v_mfma_f32_16x16x32_bf16 v[52:55], v[112:115], v[248:251], v[52:55]
    v_cvt_pk_bf16_f32 v9, v154, v158
    v_cvt_pk_bf16_f32 v13, v155, v159
    s_waitcnt lgkmcnt(0)
    v_mfma_f32_16x16x32_bf16 v[52:55], v[116:119], v[252:255], v[52:55]
    v_mfma_f32_16x16x32_bf16 v[60:63], v[120:123], v[184:187], 0
    v_mfma_f32_16x16x32_bf16 v[60:63], v[124:127], v[188:191], v[60:63]
    v_mfma_f32_16x16x32_bf16 v[60:63], v[128:131], v[192:195], v[60:63]
    v_mfma_f32_16x16x32_bf16 v[64:67], v[120:123], v[196:199], 0
    v_mfma_f32_16x16x32_bf16 v[64:67], v[124:127], v[200:203], v[64:67]
    v_mfma_f32_16x16x32_bf16 v[64:67], v[128:131], v[204:207], v[64:67]
    v_mfma_f32_16x16x32_bf16 v[68:71], v[120:123], v[208:211], 0
    v_mfma_f32_16x16x32_bf16 v[68:71], v[124:127], v[212:215], v[68:71]
    v_cvt_pk_bf16_f32 v2, v48, v52
    v_cvt_pk_bf16_f32 v6, v49, v53
    v_mfma_f32_16x16x32_bf16 v[68:71], v[128:131], v[216:219], v[68:71]
    v_cvt_pk_bf16_f32 v10, v50, v54
    v_cvt_pk_bf16_f32 v14, v51, v55
    v_mfma_f32_16x16x32_bf16 v[72:75], v[120:123], v[220:223], 0
    buffer_store_dwordx3 v[0:2], v179, s[12:15], s32 offen offset:0 sc1
    v_mfma_f32_16x16x32_bf16 v[72:75], v[124:127], v[224:227], v[72:75]
    v_cvt_pk_bf16_f32 v16, v60, v64
    v_cvt_pk_bf16_f32 v20, v61, v65
    v_mfma_f32_16x16x32_bf16 v[72:75], v[128:131], v[228:231], v[72:75]
    v_cvt_pk_bf16_f32 v24, v62, v66
    v_cvt_pk_bf16_f32 v28, v63, v67
    v_mfma_f32_16x16x32_bf16 v[76:79], v[120:123], v[232:235], 0
    buffer_store_dwordx3 v[4:6], v178, s[12:15], s32 offen offset:768 sc1
    v_mfma_f32_16x16x32_bf16 v[76:79], v[124:127], v[236:239], v[76:79]
    v_mfma_f32_16x16x32_bf16 v[76:79], v[128:131], v[240:243], v[76:79]
    v_mfma_f32_16x16x32_bf16 v[80:83], v[120:123], v[244:247], 0
    buffer_store_dwordx3 v[8:10], v179, s[12:15], s33 offen offset:192 sc1
    v_mfma_f32_16x16x32_bf16 v[80:83], v[124:127], v[248:251], v[80:83]
    v_cvt_pk_bf16_f32 v17, v68, v72
    v_cvt_pk_bf16_f32 v21, v69, v73
    v_mfma_f32_16x16x32_bf16 v[80:83], v[128:131], v[252:255], v[80:83]
    v_cvt_pk_bf16_f32 v25, v70, v74
    v_cvt_pk_bf16_f32 v29, v71, v75
    v_mfma_f32_16x16x32_bf16 v[84:87], v[132:135], v[184:187], 0
    buffer_store_dwordx3 v[12:14], v177, s[12:15], s33 offen offset:960 sc1
    v_mfma_f32_16x16x32_bf16 v[84:87], v[136:139], v[188:191], v[84:87]
    v_mfma_f32_16x16x32_bf16 v[84:87], v[140:143], v[192:195], v[84:87]
    v_mfma_f32_16x16x32_bf16 v[88:91], v[132:135], v[196:199], 0
    v_mfma_f32_16x16x32_bf16 v[88:91], v[136:139], v[200:203], v[88:91]
    v_cvt_pk_bf16_f32 v18, v76, v80
    v_cvt_pk_bf16_f32 v22, v77, v81
    v_mfma_f32_16x16x32_bf16 v[88:91], v[140:143], v[204:207], v[88:91]
    v_cvt_pk_bf16_f32 v26, v78, v82
    v_cvt_pk_bf16_f32 v30, v79, v83
    v_mfma_f32_16x16x32_bf16 v[92:95], v[132:135], v[208:211], 0
    buffer_store_dwordx3 v[16:18], v179, s[12:15], s34 offen offset:384 sc1
    v_mfma_f32_16x16x32_bf16 v[92:95], v[136:139], v[212:215], v[92:95]
    v_mfma_f32_16x16x32_bf16 v[92:95], v[140:143], v[216:219], v[92:95]
    v_mfma_f32_16x16x32_bf16 v[96:99], v[132:135], v[220:223], 0
    buffer_store_dwordx3 v[20:22], v176, s[12:15], s34 offen offset:1152 sc1
    v_mfma_f32_16x16x32_bf16 v[96:99], v[136:139], v[224:227], v[96:99]
    v_cvt_pk_bf16_f32 v32, v84, v88
    v_cvt_pk_bf16_f32 v36, v85, v89
    v_mfma_f32_16x16x32_bf16 v[96:99], v[140:143], v[228:231], v[96:99]
    v_cvt_pk_bf16_f32 v40, v86, v90
    v_cvt_pk_bf16_f32 v44, v87, v91
    v_mfma_f32_16x16x32_bf16 v[100:103], v[132:135], v[232:235], 0
    buffer_store_dwordx3 v[24:26], v179, s[12:15], s35 offen offset:576 sc1
    v_mfma_f32_16x16x32_bf16 v[100:103], v[136:139], v[236:239], v[100:103]
    v_mfma_f32_16x16x32_bf16 v[100:103], v[140:143], v[240:243], v[100:103]
    v_mfma_f32_16x16x32_bf16 v[104:107], v[132:135], v[244:247], 0
    buffer_store_dwordx3 v[28:30], v179, s[12:15], s36 offen offset:0 sc1
    v_mfma_f32_16x16x32_bf16 v[104:107], v[136:139], v[248:251], v[104:107]
    v_cvt_pk_bf16_f32 v33, v92, v96
    v_cvt_pk_bf16_f32 v37, v93, v97
    v_mfma_f32_16x16x32_bf16 v[104:107], v[140:143], v[252:255], v[104:107]
    v_cvt_pk_bf16_f32 v41, v94, v98
    v_cvt_pk_bf16_f32 v45, v95, v99
    s_nop 5
    v_cvt_pk_bf16_f32 v34, v100, v104
    buffer_store_dwordx3 v[32:34], v178, s[12:15], s36 offen offset:768 sc1
    v_cvt_pk_bf16_f32 v38, v101, v105
    v_cvt_pk_bf16_f32 v42, v102, v106
    buffer_store_dwordx3 v[36:38], v179, s[12:15], s37 offen offset:192 sc1
    v_cvt_pk_bf16_f32 v46, v103, v107
    buffer_store_dwordx3 v[40:42], v177, s[12:15], s37 offen offset:960 sc1
    buffer_store_dwordx3 v[44:46], v179, s[12:15], s38 offen offset:384 sc1
    s_branch L_fin
L_late2:
    s_and_b32 s41, s3, 1
    s_lshl_b32 s41, s41, 4
    v_and_b32 v148, 15, v157
    v_add_u32 v148, s41, v148
    v_min_u32 v148, 20, v148
    v_and_b32 v5, 48, v157
    v_mul_u32_u24 v149, 0xc0, v148
    v_add_u32 v6, 0x22350, v5
    v_add_u32 v149, v149, v6
    v_add_u32 v5, 0x20280, v5
    v_mul_u32_u24 v148, 0x190, v148
    v_add_u32 v148, v148, v5
    v_and_b32 v158, 15, v157
    v_lshrrev_b32 v159, 4, v157
    s_mul_i32 s41, s47, 0x24c0
    s_mul_i32 s43, s47, 0xc0
    s_cmp_lg_u32 s3, 3
    s_cselect_b32 s41, s41, 0
    s_add_u32 s42, s41, 0x2400
    v_lshrrev_b32 v136, 2, v158
    v_sub_u32 v137, 0, v136
    v_and_b32 v137, 3, v137
    v_xor_b32 v137, v137, v159
    v_mul_u32_u24 v138, 0xc0, v158
    v_lshl_add_u32 v146, v137, 4, v138
    v_add_u32 v170, s41, v146
    v_lshlrev_b32 v139, 4, v159
    s_mul_i32 s44, s47, 0x190
    s_add_u32 s44, s44, 0x20280
    v_add_u32 v171, s44, v139
    v_cmp_eq_u32 vcc, 1, v158
    v_add_u32 v140, 0xc0, v171
    s_add_u32 s44, s43, 0x22350
    v_cndmask_b32 v171, v171, v140, vcc
    v_lshl_add_u32 v182, v158, 2, s44
    v_mov_b32 v181, 0
    v_lshl_add_u32 v140, v159, 2, v136
    v_mul_u32_u24 v140, 0xc0, v140
    v_sub_u32 v141, 0, v159
    v_and_b32 v141, 3, v141
    v_bfe_u32 v142, v158, 1, 1
    v_xor_b32 v141, v141, v142
    v_lshl_add_u32 v140, v141, 4, v140
    v_and_b32 v142, 1, v158
    v_lshl_add_u32 v140, v142, 3, v140
    v_add_u32 v172, s41, v140
    v_xor_b32 v173, 32, v172
    v_and_b32 v142, 3, v158
    v_lshlrev_b32 v145, 3, v142
    v_add_u32 v174, s42, v145
    v_mul_u32_u24 v143, 12, v158
    v_mul_u32_u24 v144, 0xc0, v159
    v_add_u32 v179, v143, v144
    v_add_u32 v144, 0x17a00, v179
    v_mov_b32 v137, 0xff800000
    v_cmp_le_u32 vcc, 1, v159
    v_add_u32 v175, 0x23700, v156
    v_mov_b32 v150, 1
    v_cndmask_b32 v176, v179, v144, vcc
    v_cndmask_b32 v180, 0, v137, vcc
    v_cmp_le_u32 vcc, 2, v159
    v_mov_b32 v54, 0x27ff0
    s_nop 0
    v_cndmask_b32 v177, v179, v144, vcc
    v_cmp_le_u32 vcc, 3, v159
    s_bfe_u32 s43, s3, 0x10001
    s_and_b32 s44, s3, 1
    v_cndmask_b32 v178, v179, v144, vcc
    s_and_b32 s59, s3, 3
    s_lshl_b32 s59, s59, 3
    s_bfe_u32 s41, s2, 0x30003
    s_add_u32 s59, s59, s41
    s_lshl_b32 s59, s59, 10
    s_sub_u32 s59, s59, 0x11b800
    s_mov_b32 s28, 0
    s_mov_b32 s40, 0x10140
    s_mov_b32 s58, 0x540
    s_barrier
    v_lshl_add_u32 v138, v136, 3, v142
    v_mul_u32_u24 v138, 0x180, v138
    v_and_b32 v140, 2, v158
    v_xor_b32 v140, v140, v159
    v_lshl_add_u32 v138, v140, 4, v138
    v_lshlrev_b32 v140, 3, v158
    v_and_b32 v140, 64, v140
    s_mul_i32 s41, s43, 0x600
    s_add_u32 s41, s41, 0x10140
    s_mul_i32 s42, s44, 0x600
    s_add_u32 s42, s42, 0x10140
    v_add3_u32 v132, v138, v140, s41
    v_add3_u32 v134, v138, v140, s42
    v_sub_u32 v138, v138, v140
    v_add_u32 v133, s41, v138
    v_add_u32 v135, s42, v138
    s_mul_i32 s41, s44, 0xc30
    s_lshl_b32 s42, s43, 3
    s_add_u32 s41, s41, s42
    s_add_u32 s41, s41, 0x23700
    v_add_u32 v147, s41, v156
    s_mov_b32 s64, 0x3e16c740
    s_mov_b32 s28, 0
L_mw:
    s_waitcnt vmcnt(1)
    s_mov_b64 exec, 1
    ds_add_u32 v151, v150 offset:0
    s_mov_b64 exec, -1
L_polla:
    ds_read_b32 v55, v151 offset:0
    s_waitcnt lgkmcnt(0)
    v_readfirstlane_b32 s41, v55
    s_nop 0
    s_cmp_lt_u32 s41, 4
    s_cbranch_scc1 L_polla
L_mj:
    ds_read_b128 v[36:39], v135 offset:192
    ds_read_b128 v[0:3], v132 offset:0
    ds_read_b128 v[40:43], v134 offset:256
    ds_read_b128 v[4:7], v133 offset:64
    ds_read_b128 v[44:47], v135 offset:320
    ds_read_b128 v[8:11], v132 offset:128
    ds_read_b128 v[48:51], v135 offset:12480
    ds_read_b128 v[52:55], v134 offset:12544
    ds_read_b128 v[56:59], v135 offset:12608
    ds_read_b128 v[60:63], v135 offset:24768
    ds_read_b128 v[64:67], v134 offset:24832
    ds_read_b128 v[68:71], v135 offset:24896
    ds_read_b128 v[12:15], v132 offset:12288
    ds_read_b128 v[16:19], v133 offset:12352
    ds_read_b128 v[20:23], v132 offset:12416
    ds_read_b128 v[24:27], v132 offset:24576
    ds_read_b128 v[28:31], v133 offset:24640
    s_waitcnt lgkmcnt(15)
    v_mfma_f32_16x16x32_bf16 v[72:75], v[0:3], v[36:39], 0
    ds_read_b128 v[32:35], v132 offset:24704
    s_waitcnt lgkmcnt(14)
    v_mfma_f32_16x16x32_bf16 v[72:75], v[4:7], v[40:43], v[72:75]
    s_waitcnt lgkmcnt(12)
    v_mfma_f32_16x16x32_bf16 v[72:75], v[8:11], v[44:47], v[72:75]
    s_waitcnt lgkmcnt(11)
    v_mfma_f32_16x16x32_bf16 v[76:79], v[0:3], v[48:51], 0
    s_waitcnt lgkmcnt(10)
    v_mfma_f32_16x16x32_bf16 v[76:79], v[4:7], v[52:55], v[76:79]
    s_waitcnt lgkmcnt(9)
    v_mfma_f32_16x16x32_bf16 v[76:79], v[8:11], v[56:59], v[76:79]
    s_waitcnt lgkmcnt(8)
    v_mfma_f32_16x16x32_bf16 v[80:83], v[0:3], v[60:63], 0
    s_waitcnt lgkmcnt(7)
    v_mfma_f32_16x16x32_bf16 v[80:83], v[4:7], v[64:67], v[80:83]
    s_waitcnt lgkmcnt(6)
    v_mfma_f32_16x16x32_bf16 v[80:83], v[8:11], v[68:71], v[80:83]
    s_waitcnt lgkmcnt(5)
    v_mfma_f32_16x16x32_bf16 v[84:87], v[12:15], v[36:39], 0
    s_waitcnt lgkmcnt(4)
    v_mfma_f32_16x16x32_bf16 v[84:87], v[16:19], v[40:43], v[84:87]
    v_mul_f32 v72, s64, v72
    v_mul_f32 v73, s64, v73
    s_waitcnt lgkmcnt(3)
    v_mfma_f32_16x16x32_bf16 v[84:87], v[20:23], v[44:47], v[84:87]
    v_mul_f32 v74, s64, v74
    v_mul_f32 v75, s64, v75
    v_mfma_f32_16x16x32_bf16 v[88:91], v[12:15], v[48:51], 0
    v_cvt_pk_bf16_f32 v72, v72, v73
    v_cvt_pk_bf16_f32 v73, v74, v75
    v_mfma_f32_16x16x32_bf16 v[88:91], v[16:19], v[52:55], v[88:91]
    ds_write_b64 v147, v[72:73] offset:0
    v_mfma_f32_16x16x32_bf16 v[88:91], v[20:23], v[56:59], v[88:91]
    v_mul_f32 v76, s64, v76
    v_mul_f32 v77, s64, v77
    v_mfma_f32_16x16x32_bf16 v[92:95], v[12:15], v[60:63], 0
    v_mul_f32 v78, s64, v78
    v_mul_f32 v79, s64, v79
    v_mfma_f32_16x16x32_bf16 v[92:95], v[16:19], v[64:67], v[92:95]
    v_cvt_pk_bf16_f32 v76, v76, v77
    v_cvt_pk_bf16_f32 v77, v78, v79
    v_mfma_f32_16x16x32_bf16 v[92:95], v[20:23], v[68:71], v[92:95]
    ds_write_b64 v147, v[76:77] offset:6240
    s_waitcnt lgkmcnt(4)
    v_mfma_f32_16x16x32_bf16 v[96:99], v[24:27], v[36:39], 0
    v_mul_f32 v80, s64, v80
    v_mul_f32 v81, s64, v81
    s_waitcnt lgkmcnt(3)
    v_mfma_f32_16x16x32_bf16 v[96:99], v[28:31], v[40:43], v[96:99]
    v_mul_f32 v82, s64, v82
    v_mul_f32 v83, s64, v83
    s_waitcnt lgkmcnt(2)
    v_mfma_f32_16x16x32_bf16 v[96:99], v[32:35], v[44:47], v[96:99]
    v_cvt_pk_bf16_f32 v80, v80, v81
    v_cvt_pk_bf16_f32 v81, v82, v83
    v_mfma_f32_16x16x32_bf16 v[100:103], v[24:27], v[48:51], 0
    ds_write_b64 v147, v[80:81] offset:12480
    v_mfma_f32_16x16x32_bf16 v[100:103], v[28:31], v[52:55], v[100:103]
    v_mul_f32 v84, s64, v84
    v_mul_f32 v85, s64, v85
    v_mfma_f32_16x16x32_bf16 v[100:103], v[32:35], v[56:59], v[100:103]
    v_mul_f32 v86, s64, v86
    v_mul_f32 v87, s64, v87
    v_mfma_f32_16x16x32_bf16 v[104:107], v[24:27], v[60:63], 0
    v_cvt_pk_bf16_f32 v84, v84, v85
    v_cvt_pk_bf16_f32 v85, v86, v87
    v_mfma_f32_16x16x32_bf16 v[104:107], v[28:31], v[64:67], v[104:107]
    ds_write_b64 v147, v[84:85] offset:1024
    v_mfma_f32_16x16x32_bf16 v[104:107], v[32:35], v[68:71], v[104:107]
    v_mul_f32 v88, s64, v88
    v_mul_f32 v89, s64, v89
    v_mul_f32 v90, s64, v90
    v_mul_f32 v91, s64, v91
    v_cvt_pk_bf16_f32 v88, v88, v89
    v_cvt_pk_bf16_f32 v89, v90, v91
    ds_write_b64 v147, v[88:89] offset:7264
    v_mul_f32 v92, s64, v92
    v_mul_f32 v93, s64, v93
    v_mul_f32 v94, s64, v94
    v_mul_f32 v95, s64, v95
    v_cvt_pk_bf16_f32 v92, v92, v93
    v_cvt_pk_bf16_f32 v93, v94, v95
    ds_write_b64 v147, v[92:93] offset:13504
    v_mul_f32 v96, s64, v96
    v_mul_f32 v97, s64, v97
    v_mul_f32 v98, s64, v98
    v_mul_f32 v99, s64, v99
    v_cvt_pk_bf16_f32 v96, v96, v97
    v_cvt_pk_bf16_f32 v97, v98, v99
    ds_write_b64 v147, v[96:97] offset:2048
    v_mul_f32 v100, s64, v100
    v_mul_f32 v101, s64, v101
    v_mul_f32 v102, s64, v102
    v_mul_f32 v103, s64, v103
    v_cvt_pk_bf16_f32 v100, v100, v101
    v_cvt_pk_bf16_f32 v101, v102, v103
    ds_write_b64 v147, v[100:101] offset:8288
    v_mul_f32 v104, s64, v104
    v_mul_f32 v105, s64, v105
    v_mul_f32 v106, s64, v106
    v_mul_f32 v107, s64, v107
    v_cvt_pk_bf16_f32 v104, v104, v105
    v_cvt_pk_bf16_f32 v105, v106, v107
    ds_write_b64 v147, v[104:105] offset:14528
    s_waitcnt lgkmcnt(0)
    s_mov_b64 exec, 1
    ds_add_u32 v151, v150 offset:4
    s_mov_b64 exec, -1
    v_lshl_add_u32 v138, v159, 2, v136
    v_lshl_add_u32 v138, v142, 4, v138
    v_lshlrev_b32 v138, 4, v138
    v_add_u32 v147, 0x23700, v138
L_polll:
    ds_read_b32 v55, v151 offset:4
    s_waitcnt lgkmcnt(0)
    v_readfirstlane_b32 s41, v55
    s_nop 0
    s_cmp_lt_u32 s41, 4
    s_cbranch_scc1 L_polll
    s_cmp_ge_u32 s3, 6
    s_cbranch_scc1 L_zjob
    ds_read_b128 v[184:187], v175 offset:0
    ds_read_b128 v[188:191], v175 offset:1024
    ds_read_b128 v[192:195], v175 offset:2048
    ds_read_b128 v[196:199], v175 offset:3120
    ds_read_b128 v[200:203], v175 offset:4144
    ds_read_b128 v[204:207], v175 offset:5168
    ds_read_b128 v[208:211], v175 offset:6240
    ds_read_b128 v[212:215], v175 offset:7264
    ds_read_b128 v[216:219], v175 offset:8288
    ds_read_b128 v[220:223], v175 offset:9360
    ds_read_b128 v[224:227], v175 offset:10384
    ds_read_b128 v[228:231], v175 offset:11408
    ds_read_b128 v[232:235], v175 offset:12480
    ds_read_b128 v[236:239], v175 offset:13504
    ds_read_b128 v[240:243], v175 offset:14528
    ds_read_b128 v[244:247], v175 offset:15600
    ds_read_b128 v[248:251], v175 offset:16624
    ds_read_b128 v[252:255], v175 offset:17648
    s_waitcnt vmcnt(0)
    s_mov_b64 exec, 1
    ds_add_u32 v151, v150 offset:0
    s_mov_b64 exec, -1
    s_waitcnt lgkmcnt(0)
L_pollg192:
    ds_read_b32 v120, v151 offset:0
    s_waitcnt lgkmcnt(0)
    v_readfirstlane_b32 s41, v120
    s_nop 0
    s_cmp_lt_u32 s41, 8
    s_cbranch_scc1 L_pollg192
    ds_read_b128 v[108:111], v149 offset:0
    ds_read_b128 v[112:115], v149 offset:64
    ds_read_b128 v[116:119], v149 offset:128
    s_waitcnt lgkmcnt(2)
    v_mfma_f32_16x16x32_bf16 v[0:3], v[184:187], v[108:111], 0
    s_waitcnt lgkmcnt(1)
    v_mfma_f32_16x16x32_bf16 v[0:3], v[188:191], v[112:115], v[0:3]
    s_waitcnt lgkmcnt(0)
    v_mfma_f32_16x16x32_bf16 v[0:3], v[192:195], v[116:119], v[0:3]
    v_mfma_f32_16x16x32_bf16 v[4:7], v[196:199], v[108:111], 0
    v_mfma_f32_16x16x32_bf16 v[4:7], v[200:203], v[112:115], v[4:7]
    v_mfma_f32_16x16x32_bf16 v[4:7], v[204:207], v[116:119], v[4:7]
    v_mfma_f32_16x16x32_bf16 v[8:11], v[208:211], v[108:111], 0
    v_mfma_f32_16x16x32_bf16 v[8:11], v[212:215], v[112:115], v[8:11]
    v_mfma_f32_16x16x32_bf16 v[8:11], v[216:219], v[116:119], v[8:11]
    v_mfma_f32_16x16x32_bf16 v[12:15], v[220:223], v[108:111], 0
    v_mfma_f32_16x16x32_bf16 v[12:15], v[224:227], v[112:115], v[12:15]
    v_cvt_pk_bf16_f32 v0, v0, v1
    v_cvt_pk_bf16_f32 v1, v2, v3
    v_mfma_f32_16x16x32_bf16 v[12:15], v[228:231], v[116:119], v[12:15]
    v_cvt_pk_bf16_f32 v2, v4, v5
    v_cvt_pk_bf16_f32 v3, v6, v7
    v_mfma_f32_16x16x32_bf16 v[16:19], v[232:235], v[108:111], 0
    ds_write_b128 v148, v[0:3] offset:192
    v_mfma_f32_16x16x32_bf16 v[16:19], v[236:239], v[112:115], v[16:19]
    v_cvt_pk_bf16_f32 v8, v8, v9
    v_cvt_pk_bf16_f32 v9, v10, v11
    v_mfma_f32_16x16x32_bf16 v[16:19], v[240:243], v[116:119], v[16:19]
    v_cvt_pk_bf16_f32 v10, v12, v13
    v_cvt_pk_bf16_f32 v11, v14, v15
    v_mfma_f32_16x16x32_bf16 v[20:23], v[244:247], v[108:111], 0
    ds_write_b128 v148, v[8:11] offset:256
    v_mfma_f32_16x16x32_bf16 v[20:23], v[248:251], v[112:115], v[20:23]
    v_mfma_f32_16x16x32_bf16 v[20:23], v[252:255], v[116:119], v[20:23]
    s_nop 1
    v_cvt_pk_bf16_f32 v16, v16, v17
    v_cvt_pk_bf16_f32 v17, v18, v19
    s_nop 3
    v_cvt_pk_bf16_f32 v18, v20, v21
    v_cvt_pk_bf16_f32 v19, v22, v23
    ds_write_b128 v148, v[16:19] offset:320
    s_waitcnt lgkmcnt(0)
    s_mov_b64 exec, 1
    ds_add_u32 v151, v150 offset:12
    s_mov_b64 exec, -1
    s_branch L_tzd
L_zjob:
    ds_read_b64_tr_b16 v[24:25], v147 offset:0
    ds_read_b64_tr_b16 v[26:27], v147 offset:3120
    ds_read_b64_tr_b16 v[28:29], v147 offset:6240
    ds_read_b64_tr_b16 v[30:31], v147 offset:9360
    ds_read_b64_tr_b16 v[32:33], v147 offset:12480
    ds_read_b64_tr_b16 v[34:35], v147 offset:15600
    ds_read_b64_tr_b16 v[36:37], v147 offset:8
    ds_read_b64_tr_b16 v[38:39], v147 offset:3128
    ds_read_b64_tr_b16 v[40:41], v147 offset:6248
    ds_read_b64_tr_b16 v[42:43], v147 offset:9368
    ds_read_b64_tr_b16 v[44:45], v147 offset:12488
    ds_read_b64_tr_b16 v[46:47], v147 offset:15608
    ds_read_b64_tr_b16 v[48:49], v147 offset:1024
    ds_read_b64_tr_b16 v[50:51], v147 offset:4144
    ds_read_b64_tr_b16 v[52:53], v147 offset:7264
    ds_read_b64_tr_b16 v[54:55], v147 offset:10384
    ds_read_b64_tr_b16 v[56:57], v147 offset:13504
    ds_read_b64_tr_b16 v[58:59], v147 offset:16624
    ds_read_b64_tr_b16 v[60:61], v147 offset:1032
    ds_read_b64_tr_b16 v[62:63], v147 offset:4152
    ds_read_b64_tr_b16 v[64:65], v147 offset:7272
    ds_read_b64_tr_b16 v[66:67], v147 offset:10392
    ds_read_b64_tr_b16 v[68:69], v147 offset:13512
    ds_read_b64_tr_b16 v[70:71], v147 offset:16632
    ds_read_b64_tr_b16 v[72:73], v147 offset:2048
    ds_read_b64_tr_b16 v[74:75], v147 offset:5168
    ds_read_b64_tr_b16 v[76:77], v147 offset:8288
    ds_read_b64_tr_b16 v[78:79], v147 offset:11408
    ds_read_b64_tr_b16 v[80:81], v147 offset:14528
    ds_read_b64_tr_b16 v[82:83], v147 offset:17648
    ds_read_b64_tr_b16 v[84:85], v147 offset:2056
    ds_read_b64_tr_b16 v[86:87], v147 offset:5176
    ds_read_b64_tr_b16 v[88:89], v147 offset:8296
    ds_read_b64_tr_b16 v[90:91], v147 offset:11416
    ds_read_b64_tr_b16 v[92:93], v147 offset:14536
    ds_read_b64_tr_b16 v[94:95], v147 offset:17656
    s_waitcnt vmcnt(0)
    s_mov_b64 exec, 1
    ds_add_u32 v151, v150 offset:0
    s_mov_b64 exec, -1
    s_waitcnt lgkmcnt(0)
L_pollg0:
    ds_read_b32 v120, v151 offset:0
    s_waitcnt lgkmcnt(0)
    v_readfirstlane_b32 s41, v120
    s_nop 0
    s_cmp_lt_u32 s41, 8
    s_cbranch_scc1 L_pollg0
    ds_read_b128 v[108:111], v149 offset:0
    ds_read_b128 v[112:115], v149 offset:64
    ds_read_b128 v[116:119], v149 offset:128
    s_waitcnt lgkmcnt(2)
    v_mfma_f32_16x16x32_bf16 v[0:3], v[24:27], v[108:111], 0
    s_waitcnt lgkmcnt(1)
    v_mfma_f32_16x16x32_bf16 v[0:3], v[28:31], v[112:115], v[0:3]
    s_waitcnt lgkmcnt(0)
    v_mfma_f32_16x16x32_bf16 v[0:3], v[32:35], v[116:119], v[0:3]
    v_mfma_f32_16x16x32_bf16 v[4:7], v[36:39], v[108:111], 0
    v_mfma_f32_16x16x32_bf16 v[4:7], v[40:43], v[112:115], v[4:7]
    v_mfma_f32_16x16x32_bf16 v[4:7], v[44:47], v[116:119], v[4:7]
    v_mfma_f32_16x16x32_bf16 v[8:11], v[48:51], v[108:111], 0
    v_mfma_f32_16x16x32_bf16 v[8:11], v[52:55], v[112:115], v[8:11]
    v_mfma_f32_16x16x32_bf16 v[8:11], v[56:59], v[116:119], v[8:11]
    v_mfma_f32_16x16x32_bf16 v[12:15], v[60:63], v[108:111], 0
    v_mfma_f32_16x16x32_bf16 v[12:15], v[64:67], v[112:115], v[12:15]
    v_cvt_pk_bf16_f32 v0, v0, v1
    v_cvt_pk_bf16_f32 v1, v2, v3
    v_mfma_f32_16x16x32_bf16 v[12:15], v[68:71], v[116:119], v[12:15]
    v_cvt_pk_bf16_f32 v2, v4, v5
    v_cvt_pk_bf16_f32 v3, v6, v7
    v_mfma_f32_16x16x32_bf16 v[16:19], v[72:75], v[108:111], 0
    ds_write_b128 v148, v[0:3] offset:0
    v_mfma_f32_16x16x32_bf16 v[16:19], v[76:79], v[112:115], v[16:19]
    v_cvt_pk_bf16_f32 v8, v8, v9
    v_cvt_pk_bf16_f32 v9, v10, v11
    v_mfma_f32_16x16x32_bf16 v[16:19], v[80:83], v[116:119], v[16:19]
    v_cvt_pk_bf16_f32 v10, v12, v13
    v_cvt_pk_bf16_f32 v11, v14, v15
    v_mfma_f32_16x16x32_bf16 v[20:23], v[84:87], v[108:111], 0
    ds_write_b128 v148, v[8:11] offset:64
    v_mfma_f32_16x16x32_bf16 v[20:23], v[88:91], v[112:115], v[20:23]
    v_mfma_f32_16x16x32_bf16 v[20:23], v[92:95], v[116:119], v[20:23]
    s_nop 1
    v_cvt_pk_bf16_f32 v16, v16, v17
    v_cvt_pk_bf16_f32 v17, v18, v19
    s_nop 3
    v_cvt_pk_bf16_f32 v18, v20, v21
    v_cvt_pk_bf16_f32 v19, v22, v23
    ds_write_b128 v148, v[16:19] offset:128
    s_waitcnt lgkmcnt(0)
    s_mov_b64 exec, 1
    ds_add_u32 v151, v150 offset:12
    s_mov_b64 exec, -1
    ds_read_b128 v[184:187], v175 offset:0
    ds_read_b128 v[188:191], v175 offset:1024
    ds_read_b128 v[192:195], v175 offset:2048
    ds_read_b128 v[196:199], v175 offset:3120
    ds_read_b128 v[200:203], v175 offset:4144
    ds_read_b128 v[204:207], v175 offset:5168
    ds_read_b128 v[208:211], v175 offset:6240
    ds_read_b128 v[212:215], v175 offset:7264
    ds_read_b128 v[216:219], v175 offset:8288
    ds_read_b128 v[220:223], v175 offset:9360
    ds_read_b128 v[224:227], v175 offset:10384
    ds_read_b128 v[228:231], v175 offset:11408
    ds_read_b128 v[232:235], v175 offset:12480
    ds_read_b128 v[236:239], v175 offset:13504
    ds_read_b128 v[240:243], v175 offset:14528
    ds_read_b128 v[244:247], v175 offset:15600
    ds_read_b128 v[248:251], v175 offset:16624
    ds_read_b128 v[252:255], v175 offset:17648
    s_waitcnt lgkmcnt(0)
L_tzd:
    s_mov_b64 exec, 1
    ds_add_u32 v151, v150 offset:8
    s_mov_b64 exec, -1
    s_mul_i32 s41, s43, 0xc00
    s_add_u32 s41, s41, 0x16f80
    v_add_u32 v48, s41, v146
    v_lshl_add_u32 v138, v159, 3, v136
    v_mul_u32_u24 v138, 0xc0, v138
    v_and_b32 v140, 1, v158
    v_lshl_add_u32 v138, v140, 3, v138
    v_add_u32 v138, 0x1b780, v138
    s_lshl_b32 s41, s44, 1
    v_bfe_u32 v140, v158, 1, 1
    v_or_b32 v140, s41, v140
    v_lshlrev_b32 v141, 1, v159
    v_and_b32 v141, 2, v141
    v_xor_b32 v140, v140, v141
    v_lshl_add_u32 v49, v140, 4, v138
    v_xor_b32 v140, 3, v140
    v_lshl_add_u32 v50, v140, 4, v138
    s_lshl_b32 s41, s44, 4
    v_add_u32 v138, s41, v158
    s_lshl_b32 s42, s43, 3
    s_add_u32 s42, s42, 0x23700
    v_lshlrev_b32 v140, 8, v159
    v_add_u32 v140, s42, v140
    v_mul_u32_u24 v141, 43, v138
    v_lshrrev_b32 v141, 8, v141
    v_mul_u32_u24 v144, 0xc30, v138
    v_mul_u32_u24 v141, 0x4910, v141
    v_sub_u32 v144, v144, v141
    v_add_u32 v51, v144, v140
    v_add_u32 v138, 32, v138
    v_mul_u32_u24 v141, 43, v138
    v_lshrrev_b32 v141, 8, v141
    v_mul_u32_u24 v144, 0xc30, v138
    v_mul_u32_u24 v141, 0x4910, v141
    v_sub_u32 v144, v144, v141
    v_add_u32 v52, v144, v140
    v_add_u32 v138, 32, v138
    v_mul_u32_u24 v141, 43, v138
    v_lshrrev_b32 v141, 8, v141
    v_mul_u32_u24 v144, 0xc30, v138
    v_mul_u32_u24 v141, 0x4910, v141
    v_sub_u32 v144, v144, v141
    v_add_u32 v53, v144, v140
    v_mov_b32 v54, 0x27ff0
    s_setprio 2
L_polln:
    ds_read_b32 v55, v54 offset:8
    s_waitcnt lgkmcnt(0)
    v_readfirstlane_b32 s41, v55
    s_nop 0
    s_cmp_lt_u32 s41, 8
    s_cbranch_scc1 L_polln
    ds_read_b64_tr_b16 v[96:97], v49 offset:0
    ds_read_b64_tr_b16 v[98:99], v50 offset:768
    ds_read_b64_tr_b16 v[100:101], v49 offset:6144
    ds_read_b64_tr_b16 v[102:103], v50 offset:6912
    ds_read_b64_tr_b16 v[104:105], v49 offset:12288
    ds_read_b64_tr_b16 v[106:107], v50 offset:13056
    ds_read_b128 v[60:63], v48 offset:0
    ds_read_b128 v[64:67], v48 offset:64
    ds_read_b128 v[68:71], v48 offset:128
    ds_read_b64_tr_b16 v[108:109], v49 offset:64
    ds_read_b64_tr_b16 v[110:111], v50 offset:832
    ds_read_b64_tr_b16 v[112:113], v49 offset:6208
    ds_read_b64_tr_b16 v[114:115], v50 offset:6976
    ds_read_b64_tr_b16 v[116:117], v49 offset:12352
    ds_read_b64_tr_b16 v[118:119], v50 offset:13120
    ds_read_b64_tr_b16 v[120:121], v49 offset:128
    ds_read_b64_tr_b16 v[122:123], v50 offset:896
    ds_read_b64_tr_b16 v[124:125], v49 offset:6272
    ds_read_b64_tr_b16 v[126:127], v50 offset:7040
    ds_read_b64_tr_b16 v[128:129], v49 offset:12416
    ds_read_b64_tr_b16 v[130:131], v50 offset:13184
    ds_read_b128 v[72:75], v48 offset:6144
    s_waitcnt lgkmcnt(15)
    v_mfma_f32_16x16x32_bf16 v[132:135], v[60:63], v[96:99], 0
    ds_read_b128 v[76:79], v48 offset:6208
    s_waitcnt lgkmcnt(15)
    v_mfma_f32_16x16x32_bf16 v[132:135], v[64:67], v[100:103], v[132:135]
    ds_read_b128 v[80:83], v48 offset:6272
    s_waitcnt lgkmcnt(15)
    v_mfma_f32_16x16x32_bf16 v[132:135], v[68:71], v[104:107], v[132:135]
    ds_read_b128 v[84:87], v48 offset:12288
    s_waitcnt lgkmcnt(14)
    v_mfma_f32_16x16x32_bf16 v[136:139], v[60:63], v[108:111], 0
    ds_read_b128 v[88:91], v48 offset:12352
    s_waitcnt lgkmcnt(13)
    v_mfma_f32_16x16x32_bf16 v[136:139], v[64:67], v[112:115], v[136:139]
    ds_read_b128 v[92:95], v48 offset:12416
    s_waitcnt lgkmcnt(12)
    v_mfma_f32_16x16x32_bf16 v[136:139], v[68:71], v[116:119], v[136:139]
    s_waitcnt lgkmcnt(10)
    v_mfma_f32_16x16x32_bf16 v[140:143], v[60:63], v[120:123], 0
    s_waitcnt lgkmcnt(8)
    v_mfma_f32_16x16x32_bf16 v[140:143], v[64:67], v[124:127], v[140:143]
    v_cvt_pk_bf16_f32 v132, v132, v133
    v_cvt_pk_bf16_f32 v133, v134, v135
    s_waitcnt lgkmcnt(6)
    v_mfma_f32_16x16x32_bf16 v[140:143], v[68:71], v[128:131], v[140:143]
    ds_write_b64 v51, v[132:133] offset:0
    s_waitcnt lgkmcnt(6)
    v_mfma_f32_16x16x32_bf16 v[144:147], v[72:75], v[96:99], 0
    s_waitcnt lgkmcnt(5)
    v_mfma_f32_16x16x32_bf16 v[144:147], v[76:79], v[100:103], v[144:147]
    v_cvt_pk_bf16_f32 v136, v136, v137
    v_cvt_pk_bf16_f32 v137, v138, v139
    s_waitcnt lgkmcnt(4)
    v_mfma_f32_16x16x32_bf16 v[144:147], v[80:83], v[104:107], v[144:147]
    ds_write_b64 v52, v[136:137] offset:0
    v_mfma_f32_16x16x32_bf16 v[148:151], v[72:75], v[108:111], 0
    v_cvt_pk_bf16_f32 v140, v140, v141
    v_cvt_pk_bf16_f32 v141, v142, v143
    v_mfma_f32_16x16x32_bf16 v[148:151], v[76:79], v[112:115], v[148:151]
    ds_write_b64 v53, v[140:141] offset:0
    v_mfma_f32_16x16x32_bf16 v[148:151], v[80:83], v[116:119], v[148:151]
    v_mfma_f32_16x16x32_bf16 v[152:155], v[72:75], v[120:123], 0
    v_cvt_pk_bf16_f32 v144, v144, v145
    v_cvt_pk_bf16_f32 v145, v146, v147
    v_mfma_f32_16x16x32_bf16 v[152:155], v[76:79], v[124:127], v[152:155]
    ds_write_b64 v51, v[144:145] offset:1024
    v_mfma_f32_16x16x32_bf16 v[152:155], v[80:83], v[128:131], v[152:155]
    s_waitcnt lgkmcnt(6)
    v_mfma_f32_16x16x32_bf16 v[156:159], v[84:87], v[96:99], 0
    s_waitcnt lgkmcnt(5)
    v_mfma_f32_16x16x32_bf16 v[156:159], v[88:91], v[100:103], v[156:159]
    v_cvt_pk_bf16_f32 v148, v148, v149
    v_cvt_pk_bf16_f32 v149, v150, v151
    s_waitcnt lgkmcnt(4)
    v_mfma_f32_16x16x32_bf16 v[156:159], v[92:95], v[104:107], v[156:159]
    ds_write_b64 v52, v[148:149] offset:1024
    v_mfma_f32_16x16x32_bf16 v[56:59], v[84:87], v[108:111], 0
    v_mfma_f32_16x16x32_bf16 v[56:59], v[88:91], v[112:115], v[56:59]
    v_cvt_pk_bf16_f32 v152, v152, v153
    v_cvt_pk_bf16_f32 v153, v154, v155
    v_mfma_f32_16x16x32_bf16 v[56:59], v[92:95], v[116:119], v[56:59]
    ds_write_b64 v53, v[152:153] offset:1024
    v_mfma_f32_16x16x32_bf16 v[60:63], v[84:87], v[120:123], 0
    v_cvt_pk_bf16_f32 v156, v156, v157
    v_cvt_pk_bf16_f32 v157, v158, v159
    v_mfma_f32_16x16x32_bf16 v[60:63], v[88:91], v[124:127], v[60:63]
    ds_write_b64 v51, v[156:157] offset:2048
    v_mfma_f32_16x16x32_bf16 v[60:63], v[92:95], v[128:131], v[60:63]
    s_nop 0
    v_cvt_pk_bf16_f32 v56, v56, v57
    v_cvt_pk_bf16_f32 v57, v58, v59
    ds_write_b64 v52, v[56:57] offset:2048
    s_nop 3
    v_cvt_pk_bf16_f32 v60, v60, v61
    v_cvt_pk_bf16_f32 v61, v62, v63
    ds_write_b64 v53, v[60:61] offset:2048
    v_lshl_add_u32 v64, v175, 3, s59
    v_min_u32 v64, K_end-L_pc-4, v64
    s_mov_b64 exec, 0xff
    global_load_dword v183, v64, s[48:49] sc1
    s_mov_b64 exec, -1
    s_waitcnt lgkmcnt(0)
    s_barrier
    s_branch L_A0
L_dma:
    s_mul_i32 s43, s39, 0x6f2
    s_add_u32 s43, s43, s29
    s_add_u32 s43, s43, s30
    s_cmp_ge_u32 s30, 3
    s_cselect_b32 s41, s100, 0
    s_add_u32 s43, s43, s41
    s_and_b32 s44, s39, 1
    s_mul_i32 s44, s44, 7
    s_add_u32 s44, s44, s30
    s_mul_i32 m0, s44, 0x24c0
    s_mul_i32 s41, s43, 0xe071
    s_lshr_b32 s41, s41, 22
    s_mul_i32 s41, s41, 0x8fb80
    s_mul_i32 s42, s43, 0x540
    s_add_u32 s31, s41, s42
    s_cmp_lt_u32 s43, 5329
    s_cselect_b32 s10, 0x2fd00c0, 0
    buffer_load_dwordx4 v160, s[8:11], s31 offen  lds
    s_add_u32 m0, m0, 0x400
    s_nop 0
    buffer_load_dwordx4 v161, s[8:11], s31 offen  lds
    s_add_u32 m0, m0, 0x400
    s_nop 0
    buffer_load_dwordx4 v162, s[8:11], s31 offen  lds
    s_add_u32 m0, m0, 0x400
    s_nop 0
    buffer_load_dwordx4 v163, s[8:11], s31 offen  lds
    s_add_u32 m0, m0, 0x400
    s_nop 0
    buffer_load_dwordx4 v164, s[8:11], s31 offen  lds
    s_add_u32 m0, m0, 0x400
    s_nop 0
    buffer_load_dwordx4 v165, s[8:11], s31 offen  lds
    s_add_u32 m0, m0, 0x400
    s_nop 0
    buffer_load_dwordx4 v166, s[8:11], s31 offen  lds
    s_add_u32 m0, m0, 0x400
    s_nop 0
    buffer_load_dwordx4 v167, s[8:11], s31 offen  lds
    s_add_u32 m0, m0, 0x400
    s_nop 0
    buffer_load_dwordx4 v168, s[8:11], s31 offen  lds
    s_add_u32 m0, m0, 0x400
    s_mov_b64 exec, 0xfff
    buffer_load_dwordx4 v169, s[8:11], s31 offen  lds
    s_mov_b64 exec, -1
    s_setpc_b64 s[26:27]
L_xload:
    v_add_u32 v136, 64, v157
    v_mul_u32_u24 v137, 0xab, v136
    v_lshrrev_b32 v137, 11, v137
    v_mul_u32_u24 v138, 12, v137
    v_sub_u32 v138, v136, v138
    v_lshrrev_b32 v141, 2, v137
    v_and_b32 v139, 3, v137
    v_lshl_add_u32 v139, v139, 2, v141
    v_sub_u32 v141, 0, v141
    v_and_b32 v141, 3, v141
    v_xor_b32 v138, v138, v141
    v_lshlrev_b32 v138, 4, v138
    v_mad_u32_u24 v153, v137, s55, v138
    v_mul_u32_u24 v133, 0xc0, v137
    v_add_u32 v133, v133, v138
    v_mul_u32_u24 v140, 0xc0, v139
    v_add_u32 v140, v138, v140
    v_mul_u32_u24 v139, 37, v139
    v_lshrrev_b32 v141, 8, v139
    v_mad_u32_u24 v161, v141, s45, v140
    v_add_u32 v139, 0x250, v139
    v_add_u32 v140, 0xc00, v140
    v_lshrrev_b32 v141, 8, v139
    v_mad_u32_u24 v164, v141, s45, v140
    v_add_u32 v139, 0x250, v139
    v_add_u32 v140, 0xc00, v140
    v_lshrrev_b32 v141, 8, v139
    v_mad_u32_u24 v167, v141, s45, v140
    v_add_u32 v136, 0x80, v157
    v_mul_u32_u24 v137, 0xab, v136
    v_lshrrev_b32 v137, 11, v137
    v_mul_u32_u24 v138, 12, v137
    v_sub_u32 v138, v136, v138
    v_lshrrev_b32 v141, 2, v137
    v_and_b32 v139, 3, v137
    v_lshl_add_u32 v139, v139, 2, v141
    v_sub_u32 v141, 0, v141
    v_and_b32 v141, 3, v141
    v_xor_b32 v138, v138, v141
    v_lshlrev_b32 v138, 4, v138
    v_mad_u32_u24 v154, v137, s55, v138
    v_mul_u32_u24 v134, 0xc0, v137
    v_add_u32 v134, v134, v138
    v_mul_u32_u24 v140, 0xc0, v139
    v_add_u32 v140, v138, v140
    v_mul_u32_u24 v139, 37, v139
    v_lshrrev_b32 v141, 8, v139
    v_mad_u32_u24 v162, v141, s45, v140
    v_add_u32 v139, 0x250, v139
    v_add_u32 v140, 0xc00, v140
    v_lshrrev_b32 v141, 8, v139
    v_mad_u32_u24 v165, v141, s45, v140
    v_add_u32 v139, 0x250, v139
    v_add_u32 v140, 0xc00, v140
    v_lshrrev_b32 v141, 8, v139
    v_mad_u32_u24 v168, v141, s45, v140
    v_lshlrev_b32 v156, 4, v157
    v_add_u32 v169, 0x90000, v156
    v_and_b32 v158, 15, v157
    v_lshrrev_b32 v159, 4, v157
    s_mul_i32 s41, s47, 0x24c0
    s_mul_i32 s43, s47, 0xc0
    s_cmp_lg_u32 s3, 3
    s_cselect_b32 s41, s41, 0
    s_add_u32 s42, s41, 0x2400
    v_lshrrev_b32 v136, 2, v158
    v_sub_u32 v137, 0, v136
    v_and_b32 v137, 3, v137
    v_xor_b32 v137, v137, v159
    v_mul_u32_u24 v138, 0xc0, v158
    v_lshl_add_u32 v146, v137, 4, v138
    v_add_u32 v170, s41, v146
    v_lshlrev_b32 v139, 4, v159
    s_mul_i32 s44, s47, 0x190
    s_add_u32 s44, s44, 0x20280
    v_add_u32 v171, s44, v139
    v_cmp_eq_u32 vcc, 1, v158
    v_add_u32 v140, 0xc0, v171
    s_add_u32 s44, s43, 0x22350
    v_cndmask_b32 v171, v171, v140, vcc
    v_lshl_add_u32 v182, v158, 2, s44
    v_mov_b32 v181, 0
    v_lshl_add_u32 v140, v159, 2, v136
    v_mul_u32_u24 v140, 0xc0, v140
    v_sub_u32 v141, 0, v159
    v_and_b32 v141, 3, v141
    v_bfe_u32 v142, v158, 1, 1
    v_xor_b32 v141, v141, v142
    v_lshl_add_u32 v140, v141, 4, v140
    v_and_b32 v142, 1, v158
    v_lshl_add_u32 v140, v142, 3, v140
    v_add_u32 v172, s41, v140
    v_xor_b32 v173, 32, v172
    v_and_b32 v142, 3, v158
    v_lshlrev_b32 v145, 3, v142
    v_add_u32 v174, s42, v145
    v_mul_u32_u24 v143, 12, v158
    v_mul_u32_u24 v144, 0xc0, v159
    v_add_u32 v179, v143, v144
    v_add_u32 v144, 0x17a00, v179
    v_mov_b32 v137, 0xff800000
    v_cmp_le_u32 vcc, 1, v159
    v_add_u32 v175, 0x23700, v156
    v_mov_b32 v150, 1
    v_cndmask_b32 v176, v179, v144, vcc
    v_cndmask_b32 v180, 0, v137, vcc
    v_cmp_le_u32 vcc, 2, v159
    v_mov_b32 v54, 0x27ff0
    s_nop 0
    v_cndmask_b32 v177, v179, v144, vcc
    v_cmp_le_u32 vcc, 3, v159
    s_bfe_u32 s43, s3, 0x10001
    s_and_b32 s44, s3, 1
    v_cndmask_b32 v178, v179, v144, vcc
    s_and_b32 s59, s3, 3
    s_lshl_b32 s59, s59, 3
    s_bfe_u32 s41, s2, 0x30003
    s_add_u32 s59, s59, s41
    s_lshl_b32 s59, s59, 10
    s_sub_u32 s59, s59, 0x11b800
    s_mov_b32 s28, 0
    s_mov_b32 s40, 0x10140
    s_mov_b32 s58, 0x540
    v_add_u32 v171, 0x2400, v139
    v_lshrrev_b32 v170, 3, v157
    v_mul_u32_u24 v170, 0x17b40, v170
    v_lshl_add_u32 v170, v157, 7, v170
    v_add_u32 v138, 0x20340, v139
    s_mov_b32 s47, 0x540
    v_lshl_add_u32 v140, v142, 2, v136
    v_min_u32 v140, 6, v140
    v_mul_u32_u24 v141, 0x24c0, v140
    v_add_u32 v171, v171, v141
    v_mul_u32_u24 v179, 0x190, v140
    v_add_u32 v179, v179, v138
    v_mul_u32_u24 v140, 0xc0, v140
    v_add_u32 v140, 0x22350, v140
    v_add_u32 v182, v140, v139
    v_lshl_add_u32 v138, v136, 2, v159
    v_min_u32 v138, 6, v138
    v_mul_u32_u24 v138, 0x24c0, v138
    v_add_u32 v174, v174, v138
    v_lshlrev_b32 v138, 2, v159
    v_cmp_ne_u32 vcc, v138, v158
    v_add_u32 v138, 1, v138
    v_mul_u32_u24 v176, 1, v159
    v_cndmask_b32 v180, 0, v137, vcc
    v_cmp_ne_u32 vcc, v138, v158
    v_add_u32 v177, 0x90000, v143
    v_add_u32 v138, 0x80000000, v177
    v_cndmask_b32 v181, 0, v137, vcc
    v_cmp_le_u32 vcc, 3, v159
    s_mov_b32 s64, s29
    s_nop 0
    v_cndmask_b32 v178, v177, v138, vcc
    v_add_u32 v138, s100, v176
    v_cndmask_b32 v176, v176, v138, vcc
    s_barrier
L_pollw:
    ds_read_b32 v55, v151 offset:0
    s_waitcnt lgkmcnt(0)
    v_readfirstlane_b32 s41, v55
    s_nop 0
    s_cmp_lt_u32 s41, 1
    s_cbranch_scc1 L_pollw
    s_mov_b32 s30, 3
L_mdz:
    s_call_b64 s[26:27], L_dma
    s_add_u32 s30, s30, 1
    s_cmp_lt_u32 s30, 5
    s_cbranch_scc1 L_mdz
L_pollx:
    ds_read_b32 v55, v151 offset:4
    s_waitcnt lgkmcnt(0)
    v_readfirstlane_b32 s41, v55
    s_nop 0
    s_cmp_lt_u32 s41, 4
    s_cbranch_scc1 L_pollx
    s_mov_b32 s51, 0x16f80
    s_mov_b32 s53, 0x180
    s_mov_b32 s54, 0x2400
    s_mov_b32 m0, s51
    s_add_u32 s51, s51, 0x400
    buffer_load_dwordx4 v152, s[16:19], s53 offen  lds
    s_mov_b32 m0, s51
    s_add_u32 s51, s51, 0x400
    buffer_load_dwordx4 v153, s[16:19], s53 offen  lds
    s_mov_b32 m0, s51
    s_add_u32 s51, s51, 0x400
    buffer_load_dwordx4 v154, s[16:19], s53 offen  lds
    s_add_u32 s53, s53, s54
    s_mov_b32 m0, s51
    s_add_u32 s51, s51, 0x400
    buffer_load_dwordx4 v152, s[16:19], s53 offen  lds
    s_mov_b32 m0, s51
    s_add_u32 s51, s51, 0x400
    buffer_load_dwordx4 v153, s[16:19], s53 offen  lds
    s_mov_b32 m0, s51
    s_add_u32 s51, s51, 0x400
    buffer_load_dwordx4 v154, s[16:19], s53 offen  lds
    s_add_u32 s53, s53, s54
    s_mov_b32 m0, s51
    s_add_u32 s51, s51, 0x400
    buffer_load_dwordx4 v152, s[16:19], s53 offen  lds
    s_mov_b32 m0, s51
    s_add_u32 s51, s51, 0x400
    buffer_load_dwordx4 v153, s[16:19], s53 offen  lds
    s_mov_b32 m0, s51
    s_add_u32 s51, s51, 0x400
    buffer_load_dwordx4 v154, s[16:19], s53 offen  lds
    s_add_u32 s53, s53, s54
    s_mov_b32 m0, s51
    s_add_u32 s51, s51, 0x400
    buffer_load_dwordx4 v152, s[16:19], s53 offen  lds
    s_mov_b32 m0, s51
    s_add_u32 s51, s51, 0x400
    buffer_load_dwordx4 v153, s[16:19], s53 offen  lds
    s_mov_b32 m0, s51
    s_add_u32 s51, s51, 0x400
    buffer_load_dwordx4 v154, s[16:19], s53 offen  lds
    s_add_u32 s53, s53, s54
    s_mov_b32 m0, s51
    s_add_u32 s51, s51, 0x400
    buffer_load_dwordx4 v152, s[16:19], s53 offen  lds
    s_mov_b32 m0, s51
    s_add_u32 s51, s51, 0x400
    buffer_load_dwordx4 v153, s[16:19], s53 offen  lds
    s_mov_b32 m0, s51
    s_add_u32 s51, s51, 0x400
    buffer_load_dwordx4 v154, s[16:19], s53 offen  lds
    s_add_u32 s53, s53, s54
    s_mov_b32 m0, s51
    s_add_u32 s51, s51, 0x400
    buffer_load_dwordx4 v152, s[16:19], s53 offen  lds
    s_mov_b32 m0, s51
    s_add_u32 s51, s51, 0x400
    buffer_load_dwordx4 v153, s[16:19], s53 offen  lds
    s_mov_b32 m0, s51
    s_add_u32 s51, s51, 0x400
    buffer_load_dwordx4 v154, s[16:19], s53 offen  lds
    s_add_u32 s53, s53, s54
    s_mov_b32 s53, 0
    s_mov_b32 s54, 0xc00
    s_mov_b32 m0, s51
    s_add_u32 s51, s51, 0x400
    buffer_load_dwordx4 v132, s[20:23], s53 offen  lds
    s_mov_b32 m0, s51
    s_add_u32 s51, s51, 0x400
    buffer_load_dwordx4 v133, s[20:23], s53 offen  lds
    s_mov_b32 m0, s51
    s_add_u32 s51, s51, 0x400
    buffer_load_dwordx4 v134, s[20:23], s53 offen  lds
    s_add_u32 s53, s53, s54
    s_mov_b32 m0, s51
    s_add_u32 s51, s51, 0x400
    buffer_load_dwordx4 v132, s[20:23], s53 offen  lds
    s_mov_b32 m0, s51
    s_add_u32 s51, s51, 0x400
    buffer_load_dwordx4 v133, s[20:23], s53 offen  lds
    s_mov_b32 m0, s51
    s_add_u32 s51, s51, 0x400
    buffer_load_dwordx4 v134, s[20:23], s53 offen  lds
    s_add_u32 s53, s53, s54
    s_mov_b32 m0, s51
    s_add_u32 s51, s51, 0x400
    buffer_load_dwordx4 v132, s[20:23], s53 offen  lds
    s_mov_b32 m0, s51
    s_add_u32 s51, s51, 0x400
    buffer_load_dwordx4 v133, s[20:23], s53 offen  lds
    s_mov_b32 m0, s51
    s_add_u32 s51, s51, 0x400
    buffer_load_dwordx4 v134, s[20:23], s53 offen  lds
    s_add_u32 s53, s53, s54
    s_mov_b32 m0, s51
    s_add_u32 s51, s51, 0x400
    buffer_load_dwordx4 v132, s[20:23], s53 offen  lds
    s_mov_b32 m0, s51
    s_add_u32 s51, s51, 0x400
    buffer_load_dwordx4 v133, s[20:23], s53 offen  lds
    s_mov_b32 m0, s51
    s_add_u32 s51, s51, 0x400
    buffer_load_dwordx4 v134, s[20:23], s53 offen  lds
    s_add_u32 s53, s53, s54
    s_mov_b32 m0, s51
    s_add_u32 s51, s51, 0x400
    buffer_load_dwordx4 v132, s[20:23], s53 offen  lds
    s_mov_b32 m0, s51
    s_add_u32 s51, s51, 0x400
    buffer_load_dwordx4 v133, s[20:23], s53 offen  lds
    s_mov_b32 m0, s51
    s_add_u32 s51, s51, 0x400
    buffer_load_dwordx4 v134, s[20:23], s53 offen  lds
    s_add_u32 s53, s53, s54
    s_mov_b32 m0, s51
    s_add_u32 s51, s51, 0x400
    buffer_load_dwordx4 v132, s[20:23], s53 offen  lds
    s_mov_b32 m0, s51
    s_add_u32 s51, s51, 0x400
    buffer_load_dwordx4 v133, s[20:23], s53 offen  lds
    s_mov_b32 m0, s51
    s_add_u32 s51, s51, 0x400
    buffer_load_dwordx4 v134, s[20:23], s53 offen  lds
    s_add_u32 s53, s53, s54
    s_mov_b32 s30, 5
L_mdy:
    s_call_b64 s[26:27], L_dma
    s_add_u32 s30, s30, 1
    s_cmp_lt_u32 s30, 7
    s_cbranch_scc1 L_mdy
    s_waitcnt vmcnt(20)
    s_mov_b64 exec, 1
    ds_add_u32 v151, v150 offset:8
    s_mov_b64 exec, -1
    s_mov_b32 s39, 1
    s_mov_b32 s30, 0
L_mda:
    s_call_b64 s[26:27], L_dma
    s_add_u32 s30, s30, 1
    s_cmp_lt_u32 s30, 3
    s_cbranch_scc1 L_mda
    s_mov_b32 s50, 0x10001
    s_mov_b32 s51, 0x10001
    s_mov_b32 s52, 0x100010
    s_mov_b32 s53, 0x100010
    s_mov_b32 s54, 0x1000100
    s_mov_b32 s55, 0x1000100
    s_mov_b32 s56, 0x10001000
    s_mov_b32 s57, 0x10001000
    s_mov_b32 s58, 0x20002
    s_mov_b32 s59, 0x20002
    s_mov_b32 s60, 0x200020
    s_mov_b32 s61, 0x200020
    s_mov_b32 s62, 0x2000200
    s_mov_b32 s63, 0x2000200
    s_waitcnt vmcnt(30)
    s_mov_b32 s34, 0x2b5ad62e
    s_mov_b32 s32, 10
L_eloop:
    s_barrier
    s_setprio 2
    s_add_u32 s65, s64, 4
    s_add_u32 s65, s65, s100
    s_and_b32 s33, s34, 31
    s_lshr_b32 s34, s34, 5
    s_cmp_ge_u32 s32, s33
    s_cbranch_scc1 L_sv1
    s_call_b64 s[26:27], L_dmat
L_sv1:
    s_mul_i32 s42, s28, 7
    s_add_u32 s42, s42, 7
    s_min_u32 s42, s42, 21
    s_sub_u32 s41, s32, s42
    s_waitcnt vmcnt(30)
    s_cmp_ge_u32 s41, 3
    s_cbranch_scc1 L_dlo
    s_waitcnt vmcnt(20)
    s_cmp_ge_u32 s41, 2
    s_cbranch_scc1 L_dlo
    s_waitcnt vmcnt(10)
    s_cmp_ge_u32 s41, 1
    s_cbranch_scc1 L_dlo
    s_waitcnt vmcnt(0)
L_dlo:
    v_mov_b32 v170, s42
    s_mov_b64 exec, 1
    ds_write_b32 v175, v170 offset:3072
    s_mov_b64 exec, -1
    ds_read_b128 v[28:31], v171 offset:0
    ds_read_b128 v[40:43], v179 offset:0
    ds_read_b128 v[32:35], v171 offset:64
    ds_read_b128 v[44:47], v179 offset:64
    ds_read_b128 v[36:39], v171 offset:128
    ds_read_b128 v[48:51], v179 offset:128
    ds_read_b64_tr_b16 v[52:53], v174 offset:0
    ds_read_b64_tr_b16 v[54:55], v172 offset:0
    ds_read_b64_tr_b16 v[56:57], v174 offset:32
    ds_read_b64_tr_b16 v[58:59], v173 offset:0
    ds_read_b64_tr_b16 v[60:61], v174 offset:64
    ds_read_b64_tr_b16 v[62:63], v172 offset:64
    ds_read_b64_tr_b16 v[64:65], v174 offset:96
    ds_read_b64_tr_b16 v[66:67], v173 offset:64
    ds_read_b64_tr_b16 v[68:69], v174 offset:128
    s_waitcnt lgkmcnt(13)
    v_mfma_f32_16x16x32_bf16 v[12:15], v[28:31], v[40:43], v[180:183]
    ds_read_b64_tr_b16 v[70:71], v172 offset:128
    s_waitcnt lgkmcnt(12)
    v_mfma_f32_16x16x32_bf16 v[12:15], v[32:35], v[44:47], v[12:15]
    ds_read_b64_tr_b16 v[72:73], v174 offset:160
    s_waitcnt lgkmcnt(11)
    v_mfma_f32_16x16x32_bf16 v[12:15], v[36:39], v[48:51], v[12:15]
    ds_read_b64_tr_b16 v[74:75], v173 offset:128
    ds_read_b64_tr_b16 v[76:77], v172 offset:3072
    ds_read_b64_tr_b16 v[78:79], v172 offset:6144
    ds_read_b64_tr_b16 v[80:81], v173 offset:3072
    ds_read_b64_tr_b16 v[82:83], v173 offset:6144
    ds_read_b64_tr_b16 v[84:85], v172 offset:3136
    ds_read_b64_tr_b16 v[86:87], v172 offset:6208
    ds_read_b64_tr_b16 v[88:89], v173 offset:3136
    ds_read_b64_tr_b16 v[90:91], v173 offset:6208
    ds_read_b64_tr_b16 v[92:93], v172 offset:3200
    ds_read_b64_tr_b16 v[94:95], v172 offset:6272
    ds_read_b64_tr_b16 v[96:97], v173 offset:3200
    ds_read_b64_tr_b16 v[98:99], v173 offset:6272
    ds_read_b64_tr_b16 v[100:101], v172 offset:9408
    ds_read_b64_tr_b16 v[102:103], v172 offset:12480
    ds_read_b64_tr_b16 v[104:105], v173 offset:9408
    ds_read_b64_tr_b16 v[106:107], v173 offset:12480
    ds_read_b64_tr_b16 v[108:109], v172 offset:9472
    ds_read_b64_tr_b16 v[110:111], v172 offset:12544
    ds_read_b64_tr_b16 v[112:113], v173 offset:9472
    s_cmp_ge_u32 s32, s33
    s_cbranch_scc1 L_sv2
    s_call_b64 s[26:27], L_dmat
L_sv2:
    ds_read_b64_tr_b16 v[114:115], v173 offset:12544
    ds_read_b64_tr_b16 v[116:117], v172 offset:9536
    ds_read_b64_tr_b16 v[118:119], v172 offset:12608
    ds_read_b64_tr_b16 v[120:121], v173 offset:9536
    ds_read_b64_tr_b16 v[122:123], v173 offset:12608
    ds_read_b64_tr_b16 v[124:125], v172 offset:15552
    ds_read_b64_tr_b16 v[126:127], v172 offset:18816
    ds_read_b64_tr_b16 v[128:129], v173 offset:15552
    ds_read_b64_tr_b16 v[130:131], v173 offset:18816
    ds_read_b64_tr_b16 v[132:133], v172 offset:15616
    ds_read_b64_tr_b16 v[134:135], v172 offset:18880
    ds_read_b64_tr_b16 v[136:137], v173 offset:15616
    ds_read_b64_tr_b16 v[138:139], v173 offset:18880
    ds_read_b64_tr_b16 v[140:141], v172 offset:15680
    ds_read_b64_tr_b16 v[142:143], v172 offset:18944
    ds_read_b64_tr_b16 v[144:145], v173 offset:15680
    ds_read_b64_tr_b16 v[146:147], v173 offset:18944
    ds_read_b64_tr_b16 v[148:149], v172 offset:21888
    ds_read_b64_tr_b16 v[150:151], v172 offset:24960
    ds_read_b64_tr_b16 v[152:153], v173 offset:21888
    ds_read_b64_tr_b16 v[154:155], v173 offset:24960
    ds_read_b64_tr_b16 v[156:157], v172 offset:21952
    ds_read_b64_tr_b16 v[158:159], v172 offset:25024
    ds_read_b64_tr_b16 v[184:185], v173 offset:21952
    ds_read_b64_tr_b16 v[186:187], v173 offset:25024
    ds_read_b64_tr_b16 v[188:189], v172 offset:22016
    ds_read_b64_tr_b16 v[190:191], v172 offset:25088
    ds_read_b64_tr_b16 v[192:193], v173 offset:22016
    ds_read_b64_tr_b16 v[194:195], v173 offset:25088
    ds_read_b64_tr_b16 v[196:197], v172 offset:28224
    ds_read_b64_tr_b16 v[198:199], v172 offset:31296
    ds_read_b64_tr_b16 v[200:201], v173 offset:28224
    ds_read_b64_tr_b16 v[202:203], v173 offset:31296
    ds_read_b64_tr_b16 v[204:205], v172 offset:28288
    ds_read_b64_tr_b16 v[206:207], v172 offset:31360
    ds_read_b64_tr_b16 v[208:209], v173 offset:28288
    ds_read_b64_tr_b16 v[210:211], v173 offset:31360
    ds_read_b64_tr_b16 v[212:213], v172 offset:28352
    ds_read_b64_tr_b16 v[214:215], v172 offset:31424
    ds_read_b64_tr_b16 v[216:217], v173 offset:28352
    ds_read_b64_tr_b16 v[218:219], v173 offset:31424
    s_cmp_ge_u32 s32, s33
    s_cbranch_scc1 L_sv3
    s_call_b64 s[26:27], L_dmat
L_sv3:
    s_waitcnt lgkmcnt(0)
    s_and_b32 s33, s34, 31
    s_lshr_b32 s34, s34, 5
    s_barrier
    s_setprio 1
    s_cmp_ge_u32 s32, s33
    s_cbranch_scc1 L_sv4
    s_call_b64 s[26:27], L_dmat
L_sv4:
    ds_read_b128 v[0:3], v182 offset:0
    ds_read_b128 v[4:7], v182 offset:64
    ds_read_b128 v[8:11], v182 offset:128
    v_mov_b32 v27, 0
    ds_read_b64_tr_b16 v[232:233], v172 offset:34368
    ds_read_b64_tr_b16 v[234:235], v172 offset:37632
    v_mov_b32 v221, v27
    ds_read_b64_tr_b16 v[236:237], v173 offset:34368
    ds_read_b64_tr_b16 v[238:239], v173 offset:37632
    ds_read_b64_tr_b16 v[240:241], v172 offset:34432
    ds_read_b64_tr_b16 v[242:243], v172 offset:37696
    ds_read_b64_tr_b16 v[244:245], v173 offset:34432
    ds_read_b64_tr_b16 v[246:247], v173 offset:37696
    ds_read_b64_tr_b16 v[248:249], v172 offset:34496
    ds_read_b64_tr_b16 v[250:251], v172 offset:37760
    ds_read_b64_tr_b16 v[252:253], v173 offset:34496
    s_waitcnt lgkmcnt(13)
    v_max3_f32 v16, v0, v1, v2
    ds_read_b64_tr_b16 v[254:255], v173 offset:37760
    s_waitcnt lgkmcnt(13)
    v_max3_f32 v17, v3, v4, v5
    s_waitcnt lgkmcnt(12)
    v_max3_f32 v18, v6, v7, v8
    v_max3_f32 v19, v9, v10, v11
    v_max3_f32 v16, v16, v17, v12
    v_max_f32 v18, v18, v13
    v_max3_f32 v14, v16, v18, v19
    v_mov_b32 v15, v14
    s_nop 1
    v_permlane32_swap_b32 v14, v15
    v_max_f32 v14, v14, v15
    v_mov_b32 v15, v14
    s_nop 1
    v_permlane16_swap_b32 v14, v15
    v_max_f32 v14, v14, v15
    v_sub_f32 v0, v0, v14
    v_exp_f32 v0, v0
    v_sub_f32 v1, v1, v14
    v_exp_f32 v1, v1
    v_sub_f32 v2, v2, v14
    v_exp_f32 v2, v2
    v_sub_f32 v3, v3, v14
    v_exp_f32 v3, v3
    v_sub_f32 v4, v4, v14
    v_exp_f32 v4, v4
    v_sub_f32 v5, v5, v14
    v_exp_f32 v5, v5
    v_sub_f32 v6, v6, v14
    v_exp_f32 v6, v6
    v_sub_f32 v7, v7, v14
    v_exp_f32 v7, v7
    v_sub_f32 v8, v8, v14
    v_exp_f32 v8, v8
    v_sub_f32 v9, v9, v14
    v_exp_f32 v9, v9
    v_sub_f32 v10, v10, v14
    v_exp_f32 v10, v10
    v_sub_f32 v11, v11, v14
    v_exp_f32 v11, v11
    v_sub_f32 v12, v12, v14
    v_exp_f32 v12, v12
    v_sub_f32 v13, v13, v14
    v_exp_f32 v13, v13
    v_add_f32 v16, v0, v1
    v_add_f32 v17, v2, v3
    v_add_f32 v18, v4, v5
    v_add_f32 v19, v6, v7
    v_add_f32 v16, v16, v8
    v_add_f32 v17, v17, v9
    s_mul_i32 s42, s28, 7
    s_add_u32 s42, s42, 10
    s_min_u32 s42, s42, 21
    s_sub_u32 s41, s32, s42
    s_waitcnt vmcnt(30)
    s_cmp_ge_u32 s41, 3
    s_cbranch_scc1 L_dle
    s_waitcnt vmcnt(20)
    s_cmp_ge_u32 s41, 2
    s_cbranch_scc1 L_dle
    s_waitcnt vmcnt(10)
    s_cmp_ge_u32 s41, 1
    s_cbranch_scc1 L_dle
    s_waitcnt vmcnt(0)
L_dle:
    v_mov_b32 v170, s42
    s_mov_b64 exec, 1
    ds_write_b32 v175, v170 offset:3072
    s_mov_b64 exec, -1
    v_add_f32 v18, v18, v10
    v_add_f32 v19, v19, v11
    v_add_f32 v16, v16, v12
    v_add_f32 v17, v17, v13
    v_add_f32 v18, v18, v19
    v_add_f32 v16, v16, v17
    v_add_f32 v14, v16, v18
    v_mov_b32 v15, v14
    ds_read_b64_tr_b16 v[16:17], v172 offset:40832
    ds_read_b64_tr_b16 v[18:19], v172 offset:43904
    v_permlane32_swap_b32 v14, v15
    v_add_f32 v14, v14, v15
    v_mov_b32 v15, v14
    s_nop 1
    v_permlane16_swap_b32 v14, v15
    v_add_f32 v14, v14, v15
    v_rcp_f32 v14, v14
    s_nop 0
    v_mul_f32 v0, v0, v14
    v_mul_f32 v1, v1, v14
    v_mul_f32 v2, v2, v14
    v_mul_f32 v3, v3, v14
    v_mul_f32 v4, v4, v14
    v_mul_f32 v5, v5, v14
    v_mul_f32 v6, v6, v14
    v_mul_f32 v7, v7, v14
    v_mul_f32 v8, v8, v14
    v_mul_f32 v9, v9, v14
    v_mul_f32 v10, v10, v14
    v_mul_f32 v11, v11, v14
    v_mul_f32 v12, v12, v14
    v_mul_f32 v13, v13, v14
    v_cvt_pk_bf16_f32 v20, v0, v1
    v_cvt_pk_bf16_f32 v21, v2, v3
    v_cvt_pk_bf16_f32 v22, v4, v5
    v_cvt_pk_bf16_f32 v23, v6, v7
    v_cvt_pk_bf16_f32 v24, v8, v9
    v_cvt_pk_bf16_f32 v25, v10, v11
    v_cvt_pk_bf16_f32 v26, v12, v13
    v_mov_b32 v220, v26
    v_cndmask_b32 v222, 0, v20, s[50:51]
    v_cndmask_b32 v223, 0, v21, s[50:51]
    v_cndmask_b32 v224, 0, v22, s[50:51]
    v_cndmask_b32 v225, 0, v23, s[50:51]
    v_mfma_f32_16x16x32_bf16 v[28:31], v[52:55], v[220:223], 0
    v_cndmask_b32 v226, 0, v24, s[50:51]
    v_cndmask_b32 v227, 0, v25, s[50:51]
    v_mfma_f32_16x16x32_bf16 v[32:35], v[56:59], v[220:223], 0
    v_cndmask_b32 v228, 0, v20, s[52:53]
    v_cndmask_b32 v229, 0, v21, s[52:53]
    v_mfma_f32_16x16x32_bf16 v[36:39], v[60:63], v[220:223], 0
    ds_read_b64_tr_b16 v[0:1], v172 offset:40704
    v_mfma_f32_16x16x32_bf16 v[40:43], v[64:67], v[220:223], 0
    v_cndmask_b32 v230, 0, v22, s[52:53]
    ds_read_b64_tr_b16 v[2:3], v172 offset:43776
    v_mfma_f32_16x16x32_bf16 v[44:47], v[68:71], v[220:223], 0
    v_cndmask_b32 v231, 0, v23, s[52:53]
    ds_read_b64_tr_b16 v[4:5], v173 offset:40704
    v_mfma_f32_16x16x32_bf16 v[48:51], v[72:75], v[220:223], 0
    ds_read_b64_tr_b16 v[6:7], v173 offset:43776
    v_mfma_f32_16x16x32_bf16 v[28:31], v[76:79], v[224:227], v[28:31]
    ds_read_b64_tr_b16 v[8:9], v172 offset:40768
    v_mfma_f32_16x16x32_bf16 v[32:35], v[80:83], v[224:227], v[32:35]
    ds_read_b64_tr_b16 v[10:11], v172 offset:43840
    v_mfma_f32_16x16x32_bf16 v[36:39], v[84:87], v[224:227], v[36:39]
    ds_read_b64_tr_b16 v[12:13], v173 offset:40768
    v_mfma_f32_16x16x32_bf16 v[40:43], v[88:91], v[224:227], v[40:43]
    s_cmp_ge_u32 s32, s33
    s_cbranch_scc1 L_sv5
    s_call_b64 s[26:27], L_dmat
L_sv5:
    ds_read_b64_tr_b16 v[14:15], v173 offset:43840
    v_mfma_f32_16x16x32_bf16 v[44:47], v[92:95], v[224:227], v[44:47]
    v_cndmask_b32 v220, 0, v24, s[52:53]
    v_cndmask_b32 v221, 0, v25, s[52:53]
    v_mfma_f32_16x16x32_bf16 v[48:51], v[96:99], v[224:227], v[48:51]
    ds_read_b64_tr_b16 v[52:53], v173 offset:40832
    v_mfma_f32_16x16x32_bf16 v[28:31], v[100:103], v[228:231], v[28:31]
    v_cndmask_b32 v222, 0, v20, s[54:55]
    ds_read_b64_tr_b16 v[54:55], v173 offset:43904
    v_mfma_f32_16x16x32_bf16 v[32:35], v[104:107], v[228:231], v[32:35]
    v_cndmask_b32 v223, 0, v21, s[54:55]
    v_cndmask_b32 v224, 0, v22, s[54:55]
    v_mfma_f32_16x16x32_bf16 v[36:39], v[108:111], v[228:231], v[36:39]
    v_cndmask_b32 v225, 0, v23, s[54:55]
    v_cndmask_b32 v226, 0, v24, s[54:55]
    v_mfma_f32_16x16x32_bf16 v[40:43], v[112:115], v[228:231], v[40:43]
    v_cndmask_b32 v227, 0, v25, s[54:55]
    ds_read_b64_tr_b16 v[56:57], v172 offset:47040
    v_mfma_f32_16x16x32_bf16 v[44:47], v[116:119], v[228:231], v[44:47]
    ds_read_b64_tr_b16 v[58:59], v172 offset:50112
    v_mfma_f32_16x16x32_bf16 v[48:51], v[120:123], v[228:231], v[48:51]
    ds_read_b64_tr_b16 v[60:61], v173 offset:47040
    v_mfma_f32_16x16x32_bf16 v[28:31], v[124:127], v[220:223], v[28:31]
    ds_read_b64_tr_b16 v[62:63], v173 offset:50112
    v_mfma_f32_16x16x32_bf16 v[32:35], v[128:131], v[220:223], v[32:35]
    ds_read_b64_tr_b16 v[64:65], v172 offset:47104
    v_mfma_f32_16x16x32_bf16 v[36:39], v[132:135], v[220:223], v[36:39]
    ds_read_b64_tr_b16 v[66:67], v172 offset:50176
    v_mfma_f32_16x16x32_bf16 v[40:43], v[136:139], v[220:223], v[40:43]
    ds_read_b64_tr_b16 v[68:69], v173 offset:47104
    v_mfma_f32_16x16x32_bf16 v[44:47], v[140:143], v[220:223], v[44:47]
    v_cndmask_b32 v228, 0, v20, s[56:57]
    ds_read_b64_tr_b16 v[70:71], v173 offset:50176
    v_mfma_f32_16x16x32_bf16 v[48:51], v[144:147], v[220:223], v[48:51]
    v_cndmask_b32 v229, 0, v21, s[56:57]
    ds_read_b64_tr_b16 v[72:73], v172 offset:47168
    v_mfma_f32_16x16x32_bf16 v[28:31], v[148:151], v[224:227], v[28:31]
    v_cndmask_b32 v230, 0, v22, s[56:57]
    ds_read_b64_tr_b16 v[74:75], v172 offset:50240
    v_mfma_f32_16x16x32_bf16 v[32:35], v[152:155], v[224:227], v[32:35]
    v_cndmask_b32 v231, 0, v23, s[56:57]
    ds_read_b64_tr_b16 v[76:77], v173 offset:47168
    v_mfma_f32_16x16x32_bf16 v[36:39], v[156:159], v[224:227], v[36:39]
    ds_read_b64_tr_b16 v[78:79], v173 offset:50240
    v_mfma_f32_16x16x32_bf16 v[40:43], v[184:187], v[224:227], v[40:43]
    ds_read_b64_tr_b16 v[80:81], v172 offset:53184
    v_mfma_f32_16x16x32_bf16 v[44:47], v[188:191], v[224:227], v[44:47]
    ds_read_b64_tr_b16 v[82:83], v172 offset:56448
    v_mfma_f32_16x16x32_bf16 v[48:51], v[192:195], v[224:227], v[48:51]
    ds_read_b64_tr_b16 v[84:85], v173 offset:53184
    v_mfma_f32_16x16x32_bf16 v[28:31], v[196:199], v[228:231], v[28:31]
    ds_read_b64_tr_b16 v[86:87], v173 offset:56448
    v_mfma_f32_16x16x32_bf16 v[32:35], v[200:203], v[228:231], v[32:35]
    ds_read_b64_tr_b16 v[88:89], v172 offset:53248
    v_mfma_f32_16x16x32_bf16 v[36:39], v[204:207], v[228:231], v[36:39]
    ds_read_b64_tr_b16 v[90:91], v172 offset:56512
    v_mfma_f32_16x16x32_bf16 v[40:43], v[208:211], v[228:231], v[40:43]
    ds_read_b64_tr_b16 v[92:93], v173 offset:53248
    v_mfma_f32_16x16x32_bf16 v[44:47], v[212:215], v[228:231], v[44:47]
    v_cndmask_b32 v220, 0, v24, s[56:57]
    ds_read_b64_tr_b16 v[94:95], v173 offset:56512
    v_mfma_f32_16x16x32_bf16 v[48:51], v[216:219], v[228:231], v[48:51]
    v_cndmask_b32 v221, 0, v25, s[56:57]
    ds_read_b64_tr_b16 v[96:97], v172 offset:53312
    v_cndmask_b32 v222, 0, v20, s[58:59]
    ds_read_b64_tr_b16 v[98:99], v172 offset:56576
    v_cndmask_b32 v223, 0, v21, s[58:59]
    ds_read_b64_tr_b16 v[100:101], v173 offset:53312
    ds_read_b64_tr_b16 v[102:103], v173 offset:56576
    s_waitcnt lgkmcnt(15)
    v_mfma_f32_16x16x32_bf16 v[28:31], v[232:235], v[220:223], v[28:31]
    ds_read_b64_tr_b16 v[104:105], v172 offset:59520
    v_mfma_f32_16x16x32_bf16 v[32:35], v[236:239], v[220:223], v[32:35]
    ds_read_b64_tr_b16 v[106:107], v172 offset:62592
    v_mfma_f32_16x16x32_bf16 v[36:39], v[240:243], v[220:223], v[36:39]
    ds_read_b64_tr_b16 v[108:109], v173 offset:59520
    v_mfma_f32_16x16x32_bf16 v[40:43], v[244:247], v[220:223], v[40:43]
    ds_read_b64_tr_b16 v[110:111], v173 offset:62592
    v_mfma_f32_16x16x32_bf16 v[44:47], v[248:251], v[220:223], v[44:47]
    ds_read_b64_tr_b16 v[112:113], v172 offset:59584
    v_mfma_f32_16x16x32_bf16 v[48:51], v[252:255], v[220:223], v[48:51]
    ds_read_b64_tr_b16 v[114:115], v172 offset:62656
    ds_read_b64_tr_b16 v[116:117], v173 offset:59584
    v_cndmask_b32 v224, 0, v22, s[58:59]
    ds_read_b64_tr_b16 v[118:119], v173 offset:62656
    v_cndmask_b32 v225, 0, v23, s[58:59]
    ds_read_b64_tr_b16 v[120:121], v172 offset:59648
    v_cndmask_b32 v226, 0, v24, s[58:59]
    ds_read_b64_tr_b16 v[122:123], v172 offset:62720
    v_cndmask_b32 v227, 0, v25, s[58:59]
    ds_read_b64_tr_b16 v[124:125], v173 offset:59648
    ds_read_b64_tr_b16 v[126:127], v173 offset:62720
    v_mfma_f32_16x16x32_bf16 v[28:31], v[0:3], v[224:227], v[28:31]
    v_cndmask_b32 v228, 0, v20, s[60:61]
    v_cndmask_b32 v229, 0, v21, s[60:61]
    v_mfma_f32_16x16x32_bf16 v[32:35], v[4:7], v[224:227], v[32:35]
    v_cndmask_b32 v230, 0, v22, s[60:61]
    v_cndmask_b32 v231, 0, v23, s[60:61]
    v_mfma_f32_16x16x32_bf16 v[36:39], v[8:11], v[224:227], v[36:39]
    ds_read_b128 v[152:155], v175 offset:0
    v_mfma_f32_16x16x32_bf16 v[40:43], v[12:15], v[224:227], v[40:43]
    ds_read_b128 v[156:159], v175 offset:1024
    v_mfma_f32_16x16x32_bf16 v[44:47], v[16:19], v[224:227], v[44:47]
    ds_read_b128 v[184:187], v175 offset:2048
    v_mfma_f32_16x16x32_bf16 v[48:51], v[52:55], v[224:227], v[48:51]
    ds_read_b128 v[188:191], v175 offset:3120
    v_mfma_f32_16x16x32_bf16 v[28:31], v[56:59], v[228:231], v[28:31]
    ds_read_b128 v[192:195], v175 offset:4144
    v_mfma_f32_16x16x32_bf16 v[32:35], v[60:63], v[228:231], v[32:35]
    ds_read_b128 v[196:199], v175 offset:5168
    v_mfma_f32_16x16x32_bf16 v[36:39], v[64:67], v[228:231], v[36:39]
    ds_read_b128 v[200:203], v175 offset:6240
    v_mfma_f32_16x16x32_bf16 v[40:43], v[68:71], v[228:231], v[40:43]
    ds_read_b128 v[204:207], v175 offset:7264
    s_waitcnt lgkmcnt(15)
    v_mfma_f32_16x16x32_bf16 v[44:47], v[72:75], v[228:231], v[44:47]
    ds_read_b128 v[208:211], v175 offset:8288
    v_mfma_f32_16x16x32_bf16 v[48:51], v[76:79], v[228:231], v[48:51]
    v_cndmask_b32 v220, 0, v24, s[60:61]
    v_cndmask_b32 v221, 0, v25, s[60:61]
    ds_read_b128 v[212:215], v175 offset:9360
    v_cndmask_b32 v222, 0, v20, s[62:63]
    v_cndmask_b32 v223, 0, v21, s[62:63]
    ds_read_b128 v[216:219], v175 offset:10384
    ds_read_b128 v[232:235], v175 offset:11408
    v_mfma_f32_16x16x32_bf16 v[28:31], v[80:83], v[220:223], v[28:31]
    ds_read_b128 v[236:239], v175 offset:12480
    v_mfma_f32_16x16x32_bf16 v[32:35], v[84:87], v[220:223], v[32:35]
    ds_read_b128 v[240:243], v175 offset:13504
    v_mfma_f32_16x16x32_bf16 v[36:39], v[88:91], v[220:223], v[36:39]
    ds_read_b128 v[244:247], v175 offset:14528
    v_mfma_f32_16x16x32_bf16 v[40:43], v[92:95], v[220:223], v[40:43]
    ds_read_b128 v[248:251], v175 offset:15600
    v_mfma_f32_16x16x32_bf16 v[44:47], v[96:99], v[220:223], v[44:47]
    ds_read_b128 v[252:255], v175 offset:16624
    v_mfma_f32_16x16x32_bf16 v[48:51], v[100:103], v[220:223], v[48:51]
    ds_read_b128 v[0:3], v175 offset:17648
    v_cndmask_b32 v224, 0, v22, s[62:63]
    v_cndmask_b32 v225, 0, v23, s[62:63]
    v_cndmask_b32 v226, 0, v24, s[62:63]
    v_cndmask_b32 v227, 0, v25, s[62:63]
    v_add_u32 v230, s64, v176
    v_mul_u32_u24 v231, 0xe071, v230
    v_mfma_f32_16x16x32_bf16 v[28:31], v[104:107], v[224:227], v[28:31]
    v_lshrrev_b32 v231, 22, v231
    v_mul_u32_u24 v228, 0x8fb80, v231
    v_mfma_f32_16x16x32_bf16 v[32:35], v[108:111], v[224:227], v[32:35]
    v_mul_u32_u24 v230, 0x540, v230
    v_add3_u32 v228, v228, v230, v177
    s_waitcnt lgkmcnt(15)
    v_mfma_f32_16x16x32_bf16 v[36:39], v[112:115], v[224:227], v[36:39]
    v_add_u32 v230, s65, v176
    v_mul_u32_u24 v231, 0xe071, v230
    v_mfma_f32_16x16x32_bf16 v[40:43], v[116:119], v[224:227], v[40:43]
    v_cvt_pk_bf16_f32 v28, v28, v29
    v_cvt_pk_bf16_f32 v29, v30, v31
    v_mfma_f32_16x16x32_bf16 v[44:47], v[120:123], v[224:227], v[44:47]
    v_cvt_pk_bf16_f32 v30, v32, v33
    v_cvt_pk_bf16_f32 v31, v34, v35
    v_mfma_f32_16x16x32_bf16 v[48:51], v[124:127], v[224:227], v[48:51]
    v_cvt_pk_bf16_f32 v36, v36, v37
    v_cvt_pk_bf16_f32 v37, v38, v39
    v_mfma_f32_16x16x32_bf16 v[128:131], v[28:31], v[152:155], 0
    v_cvt_pk_bf16_f32 v38, v40, v41
    v_cvt_pk_bf16_f32 v39, v42, v43
    s_cmp_ge_u32 s32, s33
    s_cbranch_scc1 L_sv6
    s_call_b64 s[26:27], L_dmat
L_sv6:
    s_waitcnt lgkmcnt(14)
    v_mfma_f32_16x16x32_bf16 v[132:135], v[28:31], v[188:191], 0
    v_cvt_pk_bf16_f32 v44, v44, v45
    v_cvt_pk_bf16_f32 v45, v46, v47
    v_mfma_f32_16x16x32_bf16 v[128:131], v[36:39], v[156:159], v[128:131]
    v_cvt_pk_bf16_f32 v46, v48, v49
    v_cvt_pk_bf16_f32 v47, v50, v51
    s_waitcnt lgkmcnt(13)
    v_mfma_f32_16x16x32_bf16 v[132:135], v[36:39], v[192:195], v[132:135]
    v_lshrrev_b32 v231, 22, v231
    v_mul_u32_u24 v229, 0x8fb80, v231
    v_mfma_f32_16x16x32_bf16 v[128:131], v[44:47], v[184:187], v[128:131]
    v_mul_u32_u24 v230, 0x540, v230
    v_add3_u32 v229, v229, v230, v178
    s_waitcnt lgkmcnt(12)
    v_mfma_f32_16x16x32_bf16 v[132:135], v[44:47], v[196:199], v[132:135]
    s_waitcnt lgkmcnt(11)
    v_mfma_f32_16x16x32_bf16 v[136:139], v[28:31], v[200:203], 0
    s_waitcnt lgkmcnt(10)
    v_mfma_f32_16x16x32_bf16 v[136:139], v[36:39], v[204:207], v[136:139]
    s_waitcnt lgkmcnt(9)
    v_mfma_f32_16x16x32_bf16 v[136:139], v[44:47], v[208:211], v[136:139]
    s_waitcnt lgkmcnt(8)
    v_mfma_f32_16x16x32_bf16 v[140:143], v[28:31], v[212:215], 0
    s_waitcnt lgkmcnt(7)
    v_mfma_f32_16x16x32_bf16 v[140:143], v[36:39], v[216:219], v[140:143]
    s_waitcnt lgkmcnt(6)
    v_mfma_f32_16x16x32_bf16 v[140:143], v[44:47], v[232:235], v[140:143]
    s_waitcnt lgkmcnt(5)
    v_mfma_f32_16x16x32_bf16 v[144:147], v[28:31], v[236:239], 0
    s_waitcnt lgkmcnt(4)
    v_mfma_f32_16x16x32_bf16 v[144:147], v[36:39], v[240:243], v[144:147]
    v_cvt_pk_bf16_f32 v220, v128, v132
    v_cvt_pk_bf16_f32 v224, v129, v133
    s_waitcnt lgkmcnt(3)
    v_mfma_f32_16x16x32_bf16 v[144:147], v[44:47], v[244:247], v[144:147]
    s_waitcnt lgkmcnt(2)
    v_mfma_f32_16x16x32_bf16 v[148:151], v[28:31], v[248:251], 0
    s_waitcnt lgkmcnt(1)
    v_mfma_f32_16x16x32_bf16 v[148:151], v[36:39], v[252:255], v[148:151]
    s_waitcnt lgkmcnt(0)
    v_mfma_f32_16x16x32_bf16 v[148:151], v[44:47], v[0:3], v[148:151]
    v_cvt_pk_bf16_f32 v221, v136, v140
    v_cvt_pk_bf16_f32 v225, v137, v141
    s_nop 5
    v_cvt_pk_bf16_f32 v222, v144, v148
    buffer_store_dwordx3 v[220:222], v228, s[12:15], 0 offen offset:0 sc1
    v_cvt_pk_bf16_f32 v226, v145, v149
    buffer_store_dwordx3 v[224:226], v229, s[12:15], 0 offen offset:0 sc1
    s_cmp_eq_u32 s28, 2
    s_cbranch_scc1 L_fin
    v_add_u32 v171, s40, v171
    v_add_u32 v172, s40, v172
    v_add_u32 v173, s40, v173
    v_add_u32 v174, s40, v174
    v_add_u32 v179, 0xaf0, v179
    v_add_u32 v182, s47, v182
    s_sub_u32 s40, 0, s40
    s_sub_u32 s47, 0, s47
    s_add_u32 s64, s64, 0x6f2
    s_add_u32 s28, s28, 1
    s_waitcnt lgkmcnt(0)
    s_branch L_eloop
L_dmat:
    s_cmp_ge_u32 s32, 14
    s_cselect_b32 s39, 2, 1
    s_mul_i32 s30, s39, 7
    s_sub_u32 s30, s32, s30
    s_add_u32 s32, s32, 1
    s_mul_i32 s43, s39, 0x6f2
    s_add_u32 s43, s43, s29
    s_add_u32 s43, s43, s30
    s_cmp_ge_u32 s30, 3
    s_cselect_b32 s41, s100, 0
    s_add_u32 s43, s43, s41
    s_and_b32 s44, s39, 1
    s_mul_i32 s44, s44, 7
    s_add_u32 s44, s44, s30
    s_mul_i32 m0, s44, 0x24c0
    s_mul_i32 s41, s43, 0xe071
    s_lshr_b32 s41, s41, 22
    s_mul_i32 s41, s41, 0x8fb80
    s_mul_i32 s42, s43, 0x540
    s_add_u32 s31, s41, s42
    s_cmp_lt_u32 s43, 5329
    s_cselect_b32 s10, 0x2fd00c0, 0
    s_waitcnt vmcnt(20)
    buffer_load_dwordx4 v160, s[8:11], s31 offen  lds
    s_add_u32 m0, m0, 0x400
    s_waitcnt vmcnt(20)
    buffer_load_dwordx4 v161, s[8:11], s31 offen  lds
    s_add_u32 m0, m0, 0x400
    s_waitcnt vmcnt(20)
    buffer_load_dwordx4 v162, s[8:11], s31 offen  lds
    s_add_u32 m0, m0, 0x400
    s_waitcnt vmcnt(20)
    buffer_load_dwordx4 v163, s[8:11], s31 offen  lds
    s_add_u32 m0, m0, 0x400
    s_waitcnt vmcnt(20)
    buffer_load_dwordx4 v164, s[8:11], s31 offen  lds
    s_add_u32 m0, m0, 0x400
    s_waitcnt vmcnt(20)
    buffer_load_dwordx4 v165, s[8:11], s31 offen  lds
    s_add_u32 m0, m0, 0x400
    s_waitcnt vmcnt(20)
    buffer_load_dwordx4 v166, s[8:11], s31 offen  lds
    s_add_u32 m0, m0, 0x400
    s_waitcnt vmcnt(20)
    buffer_load_dwordx4 v167, s[8:11], s31 offen  lds
    s_add_u32 m0, m0, 0x400
    s_waitcnt vmcnt(20)
    buffer_load_dwordx4 v168, s[8:11], s31 offen  lds
    s_add_u32 m0, m0, 0x400
    s_waitcnt vmcnt(20)
    s_mov_b64 exec, 0xfff
    buffer_load_dwordx4 v169, s[8:11], s31 offen  lds
    s_mov_b64 exec, -1
    s_setpc_b64 s[26:27]
L_fin:
L_end:
    s_endpgm
K_end:
.section .rodata,"a"
.p2align 6
.amdhsa_kernel standalone__swin_window_attn__vision_kernel
  .amdhsa_next_free_vgpr 256
  .amdhsa_next_free_sgpr 102
  .amdhsa_accum_offset 256
  .amdhsa_group_segment_fixed_size 0
  .amdhsa_kernarg_size 48
  .amdhsa_user_sgpr_count 2
  .amdhsa_user_sgpr_kernarg_segment_ptr 1
  .amdhsa_system_sgpr_workgroup_id_x 1
  .amdhsa_float_denorm_mode_32 3
.end_amdhsa_kernel
```
